```python
import torch

def _softmax(x, axis=-1):
    return torch.softmax(x, dim=axis)

def _gelu(x):
    return torch.nn.functional.gelu(x, approximate='tanh')

def _silu(x):
    return torch.nn.functional.silu(x)

def _sigmoid(x):
    return torch.sigmoid(x)

def _layernorm(x, axis=-1, eps=1e-05):
    m = x.mean(dim=axis, keepdim=True)
    v = x.var(dim=axis, keepdim=True, unbiased=False)
    return (x - m) / torch.sqrt(v + eps)

def _scatter_add(tgt, idx, src, axis=0):
    return tgt.clone().index_add_(axis, idx, src)

def _segment_sum(src, seg, n):
    out = torch.zeros((n,) + src.shape[1:], dtype=src.dtype)
    return out.index_add_(0, seg, src)

def _pad(x, pw):
    flat = tuple((v for pair in reversed(pw) for v in pair))
    return torch.nn.functional.pad(x, flat)
kernel_name = 'adaLN_cond__ssm_conv_s4__glu_gated_swiglu__prompt'

def setup_inputs():

    _w = lambda a: (lambda t: t.to(torch.bfloat16) if t.is_floating_point() else t)(torch.as_tensor(a))

    def _A_setup():
        B, L, D, N = (1, 2048, 640, 128)
        A_re = -(lambda _x: torch.exp(torch.as_tensor(_x)))((lambda *s: torch.randn(*s, dtype=torch.bfloat16) * 3.2)(D, N))
        A_im = torch.pi * (lambda *s: torch.randn(*s, dtype=torch.bfloat16) * 0.05)(D, N)
        B_re = (lambda *s: torch.randn(*s, dtype=torch.bfloat16) * 0.1)(D, N)
        B_im = (lambda *s: torch.randn(*s, dtype=torch.bfloat16) * 0.1)(D, N)
        C_re = (lambda *s: torch.randn(*s, dtype=torch.bfloat16) * 0.1)(D, N)
        C_im = (lambda *s: torch.randn(*s, dtype=torch.bfloat16) * 0.1)(D, N)
        log_dt = (lambda *s: torch.randn(*s, dtype=torch.bfloat16) * 0.05)(D) * 0.5 - 4.0
        Dskip = (lambda *s: torch.randn(*s, dtype=torch.bfloat16) * 0.05)(D)
        return {'u': _w((lambda *s: torch.randn(*s, dtype=torch.bfloat16) * 0.05)(B, L, D)), 'A_re': _w(A_re), 'A_im': _w(A_im), 'B_re': _w(B_re), 'B_im': _w(B_im), 'C_re': _w(C_re), 'C_im': _w(C_im), 'log_dt': _w(log_dt), 'Dskip': _w(Dskip)}
    _A_in = _A_setup()

    def _B_setup():
        B, S, D, F = (1, 2048, 640, 1728)
        return {'x': _w((lambda *s: torch.randn(*s, dtype=torch.bfloat16) * 0.05)(B, S, D)), 'w1': _w((lambda *s: torch.randn(*s, dtype=torch.bfloat16) * 0.4)(D, F) * (2.0 / D) ** 0.5), 'w3': _w((lambda *s: torch.randn(*s, dtype=torch.bfloat16) * 0.4)(D, F) * (2.0 / D) ** 0.5), 'w2': _w((lambda *s: torch.randn(*s, dtype=torch.bfloat16) * 0.4)(F, D) * (2.0 / F) ** 0.5)}
    _B_in = _B_setup()
    return {'A_u': _A_in['u'], 'A_A_re': _A_in['A_re'], 'A_A_im': _A_in['A_im'], 'A_B_re': _A_in['B_re'], 'A_B_im': _A_in['B_im'], 'A_C_re': _A_in['C_re'], 'A_C_im': _A_in['C_im'], 'A_log_dt': _A_in['log_dt'], 'A_Dskip': _A_in['Dskip'], 'B_x': _B_in['x'], 'B_w1': _B_in['w1'], 'B_w3': _B_in['w3'], 'B_w2': _B_in['w2'], 'c': _w((lambda *s: torch.randn(*s, dtype=torch.bfloat16) * 0.2)(1, 640) * 8.0), 'w_mod': _w((lambda *s: torch.randn(*s, dtype=torch.bfloat16) * 0.2)(640, 6 * 640) * 640 ** (-0.5) * 8.0)}

def reference(A_u, A_A_re, A_A_im, A_B_re, A_B_im, A_C_re, A_C_im, A_log_dt, A_Dskip, B_x, B_w1, B_w3, B_w2, c, w_mod):

    def _A_ref(u, A_re, A_im, B_re, B_im, C_re, C_im, log_dt, Dskip):
        Bsz, L, D = u.shape
        dt = torch.exp(log_dt)[:, None]
        A = A_re + 1j * A_im
        Bc = B_re + 1j * B_im
        Cc = C_re + 1j * C_im
        logdA = dt * A
        dB = dt * Bc
        l = (lambda x, dt: x.to(dt))(torch.arange(L), A_re.dtype)
        P = torch.exp(logdA[:, :, None] * l[None, None, :])
        K = torch.einsum('dn,dnl,dn->dl', Cc, P, dB).real
        L2 = 2 * L
        Kp = _pad(K, ((0, 0), (0, L)))
        up = (lambda x, *d: x.permute(*d))(u, 0, 2, 1)
        up = _pad(up, ((0, 0), (0, 0), (0, L)))
        Kf = (lambda x, axes=(-2, -1): torch.fft.rfft2(x.float(), dim=axes))(Kp[:, None, :], axes=(-2, -1))
        Uf = (lambda x, axes=(-2, -1): torch.fft.rfft2(x.float(), dim=axes))(up[:, :, None, :], axes=(-2, -1))
        Yf = Uf * Kf[None, :, :, :]
        y = (lambda x, s, axes=(-2, -1): torch.fft.irfft2(x, s=s, dim=axes).to(torch.bfloat16))(Yf, (1, L2), axes=(-2, -1))[:, :, 0, :L]
        y = (lambda x, *d: x.permute(*d))(y, 0, 2, 1) + u * Dskip[None, None, :]
        return y

    def _B_ref(x, w1, w3, w2):
        gate = torch.einsum('bsd,df->bsf', x, w1)
        up = torch.einsum('bsd,df->bsf', x, w3)
        h = _silu(gate) * up
        out = torch.einsum('bsf,fd->bsd', h, w2)
        return out
    x = A_u
    mod = (_silu(c) @ w_mod).reshape(c.shape[0], 6, 1, -1)
    sa, ca, ga, sb, cb, gb = (mod[:, 0].clone(), mod[:, 1].clone(), mod[:, 2].clone(), mod[:, 3].clone(), mod[:, 4].clone(), mod[:, 5].clone())
    h = _layernorm(x, axis=-1) * (1 + ca) + sa
    x = x + ga * _A_ref(h, A_A_re, A_A_im, A_B_re, A_B_im, A_C_re, A_C_im, A_log_dt, A_Dskip)
    h = _layernorm(x, axis=-1) * (1 + cb) + sb
    x = x + gb * _B_ref(h, B_w1, B_w3, B_w2)
    return x
```

```asm
; @launch kernel=prep_kernel grid=(798,1,1) block=(256,1,1) lds=20480
; @launch kernel=conv_kernel grid=(640,1,1) block=(256,1,1) lds=38400
; @launch kernel=ln2_kernel grid=(128,1,1) block=(256,1,1) lds=20480
; @launch kernel=gemm1_kernel grid=(216,1,1) block=(512,1,1) lds=147456
; @launch kernel=gemm2_kernel grid=(160,1,1) block=(256,1,1) lds=98304
.amdgcn_target "amdgcn-amd-amdhsa--gfx950"
.text
.globl prep_kernel
.p2align 8
.type prep_kernel,@function
prep_kernel:
    s_cmp_ge_u32 s2, 798
    s_cbranch_scc1 .prep_done
    s_cmp_ge_u32 s2, 670
    s_cbranch_scc1 .prep_ln1
    s_cmp_ge_u32 s2, 640
    s_cbranch_scc1 .prep_mod
    s_load_dwordx4 s[4:7], s[0:1], 8
    s_load_dwordx4 s[8:11], s[0:1], 24
    s_load_dwordx4 s[12:15], s[0:1], 40
    s_load_dwordx4 s[16:19], s[0:1], 56
    s_load_dwordx2 s[20:21], s[0:1], 136
    v_lshrrev_b32 v10, 6, v0
    s_nop 0
    v_readfirstlane_b32 s23, v10
    s_waitcnt lgkmcnt(0)
    s_cmp_ge_u32 s23, 2
    s_cbranch_scc1 .prep_p_skip
    v_lshlrev_b32 v1, 1, v0
    s_lshl_b32 s3, s2, 8
    v_add_u32 v1, s3, v1
    global_load_ushort v2, v1, s[4:5]
    global_load_ushort v3, v1, s[6:7]
    global_load_ushort v4, v1, s[8:9]
    global_load_ushort v5, v1, s[10:11]
    global_load_ushort v6, v1, s[12:13]
    global_load_ushort v7, v1, s[14:15]
    s_lshl_b32 s22, s2, 1
    v_mov_b32 v8, s22
    global_load_ushort v9, v8, s[16:17]
    s_waitcnt vmcnt(0)
    v_lshlrev_b32 v2, 16, v2
    v_lshlrev_b32 v3, 16, v3
    v_lshlrev_b32 v4, 16, v4
    v_lshlrev_b32 v5, 16, v5
    v_lshlrev_b32 v6, 16, v6
    v_lshlrev_b32 v7, 16, v7
    v_lshlrev_b32 v9, 16, v9
    v_mul_f32 v9, 0x3fb8aa3b, v9
    v_exp_f32 v9, v9
    s_nop 0
    v_cvt_pk_bf16_f32 v9, v9, v9
    v_lshlrev_b32 v9, 16, v9
    v_mul_f32 v2, v2, v9
    v_mul_f32 v3, v3, v9
    v_mul_f32 v4, v4, v9
    v_mul_f32 v5, v5, v9
    v_mul_f32 v14, v6, v4
    v_fma_f32 v14, -v7, v5, v14
    v_mul_f32 v15, v6, v5
    v_fma_f32 v15, v7, v4, v15
    v_mul_f32 v12, 0x3fb8aa3b, v2
    v_mul_f32 v13, 0x3e22f983, v3
    v_lshlrev_b32 v1, 4, v0
    ds_write_b128 v1, v[12:15]
    .prep_p_skip:
    s_waitcnt lgkmcnt(0)
    s_barrier

    s_lshl_b32 s24, 1, s23
    s_lshl_b32 s25, 128, s23
    s_cmp_eq_u32 s23, 0
    s_cselect_b32 s25, 0, s25
    v_and_b32 v1, 15, v0
    v_bfe_u32 v2, v0, 4, 2
    v_lshlrev_b32 v3, s23, v1
    v_cvt_f32_u32 v4, v3
    v_lshlrev_b32 v3, 4, v3
    v_add_u32 v3, s25, v3
    v_cvt_f32_u32 v5, v3
    v_lshlrev_b32 v6, 6, v2
    v_mov_b32 v24, 0
    v_mov_b32 v25, 0
    v_mov_b32 v26, 0
    v_mov_b32 v27, 0
    s_mov_b32 s28, 0

.prep_loop:
    ds_read_b128 v[32:35], v6 offset:0
    ds_read_b128 v[36:39], v6 offset:16
    ds_read_b128 v[40:43], v6 offset:32
    ds_read_b128 v[44:47], v6 offset:48
    v_add_u32 v6, 256, v6
    s_waitcnt lgkmcnt(0)
    v_mul_f32 v8, v32, v4
    v_mul_f32 v9, v33, v4
    v_mul_f32 v10, v32, v5
    v_mul_f32 v11, v33, v5
    v_exp_f32 v8, v8
    v_fract_f32 v9, v9
    v_exp_f32 v10, v10
    v_fract_f32 v11, v11
    v_sin_f32 v12, v9
    v_cos_f32 v13, v9
    v_sin_f32 v14, v11
    v_cos_f32 v15, v11
    v_mul_f32 v48, v8, v13
    v_mul_f32 v49, v8, v12
    v_mul_f32 v16, v34, v15
    v_fma_f32 v16, -v35, v14, v16
    v_mul_f32 v17, v34, v14
    v_fma_f32 v17, v35, v15, v17
    v_mul_f32 v56, v10, v16
    v_mul_f32 v57, -v10, v17

    v_mul_f32 v8, v36, v4
    v_mul_f32 v9, v37, v4
    v_mul_f32 v10, v36, v5
    v_mul_f32 v11, v37, v5
    v_exp_f32 v8, v8
    v_fract_f32 v9, v9
    v_exp_f32 v10, v10
    v_fract_f32 v11, v11
    v_sin_f32 v12, v9
    v_cos_f32 v13, v9
    v_sin_f32 v14, v11
    v_cos_f32 v15, v11
    v_mul_f32 v50, v8, v13
    v_mul_f32 v51, v8, v12
    v_mul_f32 v16, v38, v15
    v_fma_f32 v16, -v39, v14, v16
    v_mul_f32 v17, v38, v14
    v_fma_f32 v17, v39, v15, v17
    v_mul_f32 v58, v10, v16
    v_mul_f32 v59, -v10, v17

    v_mul_f32 v8, v40, v4
    v_mul_f32 v9, v41, v4
    v_mul_f32 v10, v40, v5
    v_mul_f32 v11, v41, v5
    v_exp_f32 v8, v8
    v_fract_f32 v9, v9
    v_exp_f32 v10, v10
    v_fract_f32 v11, v11
    v_sin_f32 v12, v9
    v_cos_f32 v13, v9
    v_sin_f32 v14, v11
    v_cos_f32 v15, v11
    v_mul_f32 v52, v8, v13
    v_mul_f32 v53, v8, v12
    v_mul_f32 v16, v42, v15
    v_fma_f32 v16, -v43, v14, v16
    v_mul_f32 v17, v42, v14
    v_fma_f32 v17, v43, v15, v17
    v_mul_f32 v60, v10, v16
    v_mul_f32 v61, -v10, v17

    v_mul_f32 v8, v44, v4
    v_mul_f32 v9, v45, v4
    v_mul_f32 v10, v44, v5
    v_mul_f32 v11, v45, v5
    v_exp_f32 v8, v8
    v_fract_f32 v9, v9
    v_exp_f32 v10, v10
    v_fract_f32 v11, v11
    v_sin_f32 v12, v9
    v_cos_f32 v13, v9
    v_sin_f32 v14, v11
    v_cos_f32 v15, v11
    v_mul_f32 v54, v8, v13
    v_mul_f32 v55, v8, v12
    v_mul_f32 v16, v46, v15
    v_fma_f32 v16, -v47, v14, v16
    v_mul_f32 v17, v46, v14
    v_fma_f32 v17, v47, v15, v17
    v_mul_f32 v62, v10, v16
    v_mul_f32 v63, -v10, v17

    v_cvt_pk_bf16_f32 v64, v48, v49
    v_lshlrev_b32 v8, 16, v64
    v_and_b32 v9, 0xffff0000, v64
    v_sub_f32 v8, v48, v8
    v_sub_f32 v9, v49, v9
    v_cvt_pk_bf16_f32 v68, v8, v9

    v_cvt_pk_bf16_f32 v65, v50, v51
    v_lshlrev_b32 v8, 16, v65
    v_and_b32 v9, 0xffff0000, v65
    v_sub_f32 v8, v50, v8
    v_sub_f32 v9, v51, v9
    v_cvt_pk_bf16_f32 v69, v8, v9

    v_cvt_pk_bf16_f32 v66, v52, v53
    v_lshlrev_b32 v8, 16, v66
    v_and_b32 v9, 0xffff0000, v66
    v_sub_f32 v8, v52, v8
    v_sub_f32 v9, v53, v9
    v_cvt_pk_bf16_f32 v70, v8, v9

    v_cvt_pk_bf16_f32 v67, v54, v55
    v_lshlrev_b32 v8, 16, v67
    v_and_b32 v9, 0xffff0000, v67
    v_sub_f32 v8, v54, v8
    v_sub_f32 v9, v55, v9
    v_cvt_pk_bf16_f32 v71, v8, v9

    v_cvt_pk_bf16_f32 v72, v56, v57
    v_lshlrev_b32 v8, 16, v72
    v_and_b32 v9, 0xffff0000, v72
    v_sub_f32 v8, v56, v8
    v_sub_f32 v9, v57, v9
    v_cvt_pk_bf16_f32 v76, v8, v9

    v_cvt_pk_bf16_f32 v73, v58, v59
    v_lshlrev_b32 v8, 16, v73
    v_and_b32 v9, 0xffff0000, v73
    v_sub_f32 v8, v58, v8
    v_sub_f32 v9, v59, v9
    v_cvt_pk_bf16_f32 v77, v8, v9

    v_cvt_pk_bf16_f32 v74, v60, v61
    v_lshlrev_b32 v8, 16, v74
    v_and_b32 v9, 0xffff0000, v74
    v_sub_f32 v8, v60, v8
    v_sub_f32 v9, v61, v9
    v_cvt_pk_bf16_f32 v78, v8, v9

    v_cvt_pk_bf16_f32 v75, v62, v63
    v_lshlrev_b32 v8, 16, v75
    v_and_b32 v9, 0xffff0000, v75
    v_sub_f32 v8, v62, v8
    v_sub_f32 v9, v63, v9
    v_cvt_pk_bf16_f32 v79, v8, v9

    s_nop 1
    v_mfma_f32_16x16x32_bf16 v[24:27], v[72:75], v[64:67], v[24:27]
    v_mfma_f32_16x16x32_bf16 v[24:27], v[72:75], v[68:71], v[24:27]
    v_mfma_f32_16x16x32_bf16 v[24:27], v[76:79], v[64:67], v[24:27]
    s_add_u32 s28, s28, 1
    s_cmp_lt_u32 s28, 8
    s_cbranch_scc1 .prep_loop
    s_nop 7
    s_nop 3
    s_lshl_b32 s28, s23, 7
    s_add_u32 s29, s28, 128
    s_cmp_eq_u32 s23, 0
    s_cselect_b32 s28, 0, s29
    s_cselect_b32 s29, 16, 8
    s_cmp_eq_u32 s23, 3
    s_cselect_b32 s29, 9, s29
    v_lshlrev_b32 v8, 6, v2
    v_add_u32 v8, v8, v1
    v_add_u32 v8, s28, v8
    v_lshlrev_b32 v8, 2, v8
    v_add_u32 v8, 2048, v8
    v_lshlrev_b32 v9, 2, v2

    v_add_u32 v10, 0, v9
    v_cmp_gt_u32 vcc, s29, v10
    s_and_saveexec_b64 s[30:31], vcc
    ds_write_b32 v8, v24 offset:0
    s_mov_b64 exec, s[30:31]

    v_add_u32 v10, 1, v9
    v_cmp_gt_u32 vcc, s29, v10
    s_and_saveexec_b64 s[30:31], vcc
    ds_write_b32 v8, v25 offset:64
    s_mov_b64 exec, s[30:31]

    v_add_u32 v10, 2, v9
    v_cmp_gt_u32 vcc, s29, v10
    s_and_saveexec_b64 s[30:31], vcc
    ds_write_b32 v8, v26 offset:128
    s_mov_b64 exec, s[30:31]

    v_add_u32 v10, 3, v9
    v_cmp_gt_u32 vcc, s29, v10
    s_and_saveexec_b64 s[30:31], vcc
    ds_write_b32 v8, v27 offset:192
    s_mov_b64 exec, s[30:31]

    .prep_kw:
    s_lshl_b32 s22, s2, 1
    v_mov_b32 v1, s22
    global_load_ushort v2, v1, s[18:19]
    s_waitcnt lgkmcnt(0)
    s_barrier
    v_lshlrev_b32 v3, 3, v0

    v_add_u32 v4, 0, v3
    v_cvt_f32_u32 v4, v4
    v_cvt_pk_bf16_f32 v4, v4, v4
    v_lshlrev_b32 v4, 16, v4
    v_cvt_u32_f32 v5, v4
    v_lshrrev_b32 v6, 23, v4
    v_subrev_u32 v6, 134, v6
    v_max_i32 v6, 0, v6
    v_lshrrev_b32 v5, v6, v5
    v_lshlrev_b32 v6, 7, v6
    v_add_u32 v5, v5, v6
    v_lshlrev_b32 v5, 2, v5
    v_add_u32 v5, 2048, v5
    ds_read_b32 v32, v5

    v_add_u32 v4, 1, v3
    v_cvt_f32_u32 v4, v4
    v_cvt_pk_bf16_f32 v4, v4, v4
    v_lshlrev_b32 v4, 16, v4
    v_cvt_u32_f32 v5, v4
    v_lshrrev_b32 v6, 23, v4
    v_subrev_u32 v6, 134, v6
    v_max_i32 v6, 0, v6
    v_lshrrev_b32 v5, v6, v5
    v_lshlrev_b32 v6, 7, v6
    v_add_u32 v5, v5, v6
    v_lshlrev_b32 v5, 2, v5
    v_add_u32 v5, 2048, v5
    ds_read_b32 v33, v5

    v_add_u32 v4, 2, v3
    v_cvt_f32_u32 v4, v4
    v_cvt_pk_bf16_f32 v4, v4, v4
    v_lshlrev_b32 v4, 16, v4
    v_cvt_u32_f32 v5, v4
    v_lshrrev_b32 v6, 23, v4
    v_subrev_u32 v6, 134, v6
    v_max_i32 v6, 0, v6
    v_lshrrev_b32 v5, v6, v5
    v_lshlrev_b32 v6, 7, v6
    v_add_u32 v5, v5, v6
    v_lshlrev_b32 v5, 2, v5
    v_add_u32 v5, 2048, v5
    ds_read_b32 v34, v5

    v_add_u32 v4, 3, v3
    v_cvt_f32_u32 v4, v4
    v_cvt_pk_bf16_f32 v4, v4, v4
    v_lshlrev_b32 v4, 16, v4
    v_cvt_u32_f32 v5, v4
    v_lshrrev_b32 v6, 23, v4
    v_subrev_u32 v6, 134, v6
    v_max_i32 v6, 0, v6
    v_lshrrev_b32 v5, v6, v5
    v_lshlrev_b32 v6, 7, v6
    v_add_u32 v5, v5, v6
    v_lshlrev_b32 v5, 2, v5
    v_add_u32 v5, 2048, v5
    ds_read_b32 v35, v5

    v_add_u32 v4, 4, v3
    v_cvt_f32_u32 v4, v4
    v_cvt_pk_bf16_f32 v4, v4, v4
    v_lshlrev_b32 v4, 16, v4
    v_cvt_u32_f32 v5, v4
    v_lshrrev_b32 v6, 23, v4
    v_subrev_u32 v6, 134, v6
    v_max_i32 v6, 0, v6
    v_lshrrev_b32 v5, v6, v5
    v_lshlrev_b32 v6, 7, v6
    v_add_u32 v5, v5, v6
    v_lshlrev_b32 v5, 2, v5
    v_add_u32 v5, 2048, v5
    ds_read_b32 v36, v5

    v_add_u32 v4, 5, v3
    v_cvt_f32_u32 v4, v4
    v_cvt_pk_bf16_f32 v4, v4, v4
    v_lshlrev_b32 v4, 16, v4
    v_cvt_u32_f32 v5, v4
    v_lshrrev_b32 v6, 23, v4
    v_subrev_u32 v6, 134, v6
    v_max_i32 v6, 0, v6
    v_lshrrev_b32 v5, v6, v5
    v_lshlrev_b32 v6, 7, v6
    v_add_u32 v5, v5, v6
    v_lshlrev_b32 v5, 2, v5
    v_add_u32 v5, 2048, v5
    ds_read_b32 v37, v5

    v_add_u32 v4, 6, v3
    v_cvt_f32_u32 v4, v4
    v_cvt_pk_bf16_f32 v4, v4, v4
    v_lshlrev_b32 v4, 16, v4
    v_cvt_u32_f32 v5, v4
    v_lshrrev_b32 v6, 23, v4
    v_subrev_u32 v6, 134, v6
    v_max_i32 v6, 0, v6
    v_lshrrev_b32 v5, v6, v5
    v_lshlrev_b32 v6, 7, v6
    v_add_u32 v5, v5, v6
    v_lshlrev_b32 v5, 2, v5
    v_add_u32 v5, 2048, v5
    ds_read_b32 v38, v5

    v_add_u32 v4, 7, v3
    v_cvt_f32_u32 v4, v4
    v_cvt_pk_bf16_f32 v4, v4, v4
    v_lshlrev_b32 v4, 16, v4
    v_cvt_u32_f32 v5, v4
    v_lshrrev_b32 v6, 23, v4
    v_subrev_u32 v6, 134, v6
    v_max_i32 v6, 0, v6
    v_lshrrev_b32 v5, v6, v5
    v_lshlrev_b32 v6, 7, v6
    v_add_u32 v5, v5, v6
    v_lshlrev_b32 v5, 2, v5
    v_add_u32 v5, 2048, v5
    ds_read_b32 v39, v5

    s_waitcnt vmcnt(0) lgkmcnt(0)
    v_lshlrev_b32 v2, 16, v2
    v_cmp_eq_u32 vcc, 0, v0
    s_nop 1
    v_cndmask_b32 v2, 0, v2, vcc
    v_add_f32 v32, v32, v2
    v_cvt_pk_bf16_f32 v8, v32, v33
    v_cvt_pk_bf16_f32 v9, v34, v35
    v_cvt_pk_bf16_f32 v10, v36, v37
    v_cvt_pk_bf16_f32 v11, v38, v39
    s_lshl_b32 s22, s2, 12
    s_add_u32 s22, s22, 65536
    v_lshlrev_b32 v1, 4, v0
    v_add_u32 v1, s22, v1
    global_store_dwordx4 v1, v[8:11], s[20:21]
    s_branch .prep_done

.prep_mod:
    s_load_dwordx4 s[4:7], s[0:1], 104
    s_load_dwordx2 s[20:21], s[0:1], 136
    v_lshrrev_b32 v10, 6, v0
    s_nop 0
    v_readfirstlane_b32 s23, v10
    s_sub_u32 s22, s2, 640
    s_waitcnt lgkmcnt(0)

    v_add_u32 v11, 0, v0
    v_cmp_gt_u32 vcc, 320, v11
    s_and_saveexec_b64 s[30:31], vcc
    v_lshlrev_b32 v1, 2, v11
    global_load_dword v2, v1, s[4:5]
    s_waitcnt vmcnt(0)
    v_lshlrev_b32 v3, 16, v2
    v_and_b32 v4, 0xffff0000, v2

    v_mul_f32 v5, 0xbfb8aa3b, v3
    v_exp_f32 v5, v5
    s_nop 0
    v_add_f32 v5, 1.0, v5
    v_rcp_f32 v5, v5
    s_nop 0
    v_mul_f32 v3, v3, v5

    v_mul_f32 v5, 0xbfb8aa3b, v4
    v_exp_f32 v5, v5
    s_nop 0
    v_add_f32 v5, 1.0, v5
    v_rcp_f32 v5, v5
    s_nop 0
    v_mul_f32 v4, v4, v5

    v_cvt_pk_bf16_f32 v5, v3, v4
    v_lshlrev_b32 v6, 16, v5
    v_and_b32 v7, 0xffff0000, v5
    v_lshlrev_b32 v1, 3, v11
    ds_write_b64 v1, v[6:7]
    s_mov_b64 exec, s[30:31]

    v_add_u32 v11, 256, v0
    v_cmp_gt_u32 vcc, 320, v11
    s_and_saveexec_b64 s[30:31], vcc
    v_lshlrev_b32 v1, 2, v11
    global_load_dword v2, v1, s[4:5]
    s_waitcnt vmcnt(0)
    v_lshlrev_b32 v3, 16, v2
    v_and_b32 v4, 0xffff0000, v2

    v_mul_f32 v5, 0xbfb8aa3b, v3
    v_exp_f32 v5, v5
    s_nop 0
    v_add_f32 v5, 1.0, v5
    v_rcp_f32 v5, v5
    s_nop 0
    v_mul_f32 v3, v3, v5

    v_mul_f32 v5, 0xbfb8aa3b, v4
    v_exp_f32 v5, v5
    s_nop 0
    v_add_f32 v5, 1.0, v5
    v_rcp_f32 v5, v5
    s_nop 0
    v_mul_f32 v4, v4, v5

    v_cvt_pk_bf16_f32 v5, v3, v4
    v_lshlrev_b32 v6, 16, v5
    v_and_b32 v7, 0xffff0000, v5
    v_lshlrev_b32 v1, 3, v11
    ds_write_b64 v1, v[6:7]
    s_mov_b64 exec, s[30:31]

    s_waitcnt lgkmcnt(0)
    s_barrier
    v_and_b32 v1, 63, v0
    s_lshl_b32 s24, s22, 8
    v_lshlrev_b32 v2, 2, v1
    v_add_u32 v2, s24, v2
    s_mul_i32 s25, s23, 160*7680
    v_add_u32 v2, s25, v2
    s_mul_i32 s26, s23, 640
    v_mov_b32 v3, s26
    v_mov_b32 v40, 0
    v_mov_b32 v41, 0
    s_mov_b32 s27, 0

.prep_mloop:
    global_load_dword v60, v2, s[6:7]
    v_add_u32 v2, 7680, v2
    global_load_dword v61, v2, s[6:7]
    v_add_u32 v2, 7680, v2
    global_load_dword v62, v2, s[6:7]
    v_add_u32 v2, 7680, v2
    global_load_dword v63, v2, s[6:7]
    v_add_u32 v2, 7680, v2
    global_load_dword v64, v2, s[6:7]
    v_add_u32 v2, 7680, v2
    global_load_dword v65, v2, s[6:7]
    v_add_u32 v2, 7680, v2
    global_load_dword v66, v2, s[6:7]
    v_add_u32 v2, 7680, v2
    global_load_dword v67, v2, s[6:7]
    v_add_u32 v2, 7680, v2
    global_load_dword v68, v2, s[6:7]
    v_add_u32 v2, 7680, v2
    global_load_dword v69, v2, s[6:7]
    v_add_u32 v2, 7680, v2
    global_load_dword v70, v2, s[6:7]
    v_add_u32 v2, 7680, v2
    global_load_dword v71, v2, s[6:7]
    v_add_u32 v2, 7680, v2
    global_load_dword v72, v2, s[6:7]
    v_add_u32 v2, 7680, v2
    global_load_dword v73, v2, s[6:7]
    v_add_u32 v2, 7680, v2
    global_load_dword v74, v2, s[6:7]
    v_add_u32 v2, 7680, v2
    global_load_dword v75, v2, s[6:7]
    v_add_u32 v2, 7680, v2
    global_load_dword v76, v2, s[6:7]
    v_add_u32 v2, 7680, v2
    global_load_dword v77, v2, s[6:7]
    v_add_u32 v2, 7680, v2
    global_load_dword v78, v2, s[6:7]
    v_add_u32 v2, 7680, v2
    global_load_dword v79, v2, s[6:7]
    v_add_u32 v2, 7680, v2
    global_load_dword v80, v2, s[6:7]
    v_add_u32 v2, 7680, v2
    global_load_dword v81, v2, s[6:7]
    v_add_u32 v2, 7680, v2
    global_load_dword v82, v2, s[6:7]
    v_add_u32 v2, 7680, v2
    global_load_dword v83, v2, s[6:7]
    v_add_u32 v2, 7680, v2
    global_load_dword v84, v2, s[6:7]
    v_add_u32 v2, 7680, v2
    global_load_dword v85, v2, s[6:7]
    v_add_u32 v2, 7680, v2
    global_load_dword v86, v2, s[6:7]
    v_add_u32 v2, 7680, v2
    global_load_dword v87, v2, s[6:7]
    v_add_u32 v2, 7680, v2
    global_load_dword v88, v2, s[6:7]
    v_add_u32 v2, 7680, v2
    global_load_dword v89, v2, s[6:7]
    v_add_u32 v2, 7680, v2
    global_load_dword v90, v2, s[6:7]
    v_add_u32 v2, 7680, v2
    global_load_dword v91, v2, s[6:7]
    v_add_u32 v2, 7680, v2
    global_load_dword v92, v2, s[6:7]
    v_add_u32 v2, 7680, v2
    global_load_dword v93, v2, s[6:7]
    v_add_u32 v2, 7680, v2
    global_load_dword v94, v2, s[6:7]
    v_add_u32 v2, 7680, v2
    global_load_dword v95, v2, s[6:7]
    v_add_u32 v2, 7680, v2
    global_load_dword v96, v2, s[6:7]
    v_add_u32 v2, 7680, v2
    global_load_dword v97, v2, s[6:7]
    v_add_u32 v2, 7680, v2
    global_load_dword v98, v2, s[6:7]
    v_add_u32 v2, 7680, v2
    global_load_dword v99, v2, s[6:7]
    v_add_u32 v2, 7680, v2
    ds_read_b128 v[100:103], v3 offset:0
    ds_read_b128 v[104:107], v3 offset:16
    ds_read_b128 v[108:111], v3 offset:32
    ds_read_b128 v[112:115], v3 offset:48
    ds_read_b128 v[116:119], v3 offset:64
    ds_read_b128 v[120:123], v3 offset:80
    ds_read_b128 v[124:127], v3 offset:96
    ds_read_b128 v[128:131], v3 offset:112
    ds_read_b128 v[132:135], v3 offset:128
    ds_read_b128 v[136:139], v3 offset:144
    v_add_u32 v3, 160, v3
    s_waitcnt vmcnt(39) lgkmcnt(0)
    v_lshlrev_b32 v4, 16, v60
    v_and_b32 v5, 0xffff0000, v60
    v_fma_f32 v40, v4, v100, v40
    v_fma_f32 v41, v5, v100, v41
    s_waitcnt vmcnt(38) lgkmcnt(0)
    v_lshlrev_b32 v4, 16, v61
    v_and_b32 v5, 0xffff0000, v61
    v_fma_f32 v40, v4, v101, v40
    v_fma_f32 v41, v5, v101, v41
    s_waitcnt vmcnt(37) lgkmcnt(0)
    v_lshlrev_b32 v4, 16, v62
    v_and_b32 v5, 0xffff0000, v62
    v_fma_f32 v40, v4, v102, v40
    v_fma_f32 v41, v5, v102, v41
    s_waitcnt vmcnt(36) lgkmcnt(0)
    v_lshlrev_b32 v4, 16, v63
    v_and_b32 v5, 0xffff0000, v63
    v_fma_f32 v40, v4, v103, v40
    v_fma_f32 v41, v5, v103, v41
    s_waitcnt vmcnt(35) lgkmcnt(0)
    v_lshlrev_b32 v4, 16, v64
    v_and_b32 v5, 0xffff0000, v64
    v_fma_f32 v40, v4, v104, v40
    v_fma_f32 v41, v5, v104, v41
    s_waitcnt vmcnt(34) lgkmcnt(0)
    v_lshlrev_b32 v4, 16, v65
    v_and_b32 v5, 0xffff0000, v65
    v_fma_f32 v40, v4, v105, v40
    v_fma_f32 v41, v5, v105, v41
    s_waitcnt vmcnt(33) lgkmcnt(0)
    v_lshlrev_b32 v4, 16, v66
    v_and_b32 v5, 0xffff0000, v66
    v_fma_f32 v40, v4, v106, v40
    v_fma_f32 v41, v5, v106, v41
    s_waitcnt vmcnt(32) lgkmcnt(0)
    v_lshlrev_b32 v4, 16, v67
    v_and_b32 v5, 0xffff0000, v67
    v_fma_f32 v40, v4, v107, v40
    v_fma_f32 v41, v5, v107, v41
    s_waitcnt vmcnt(31) lgkmcnt(0)
    v_lshlrev_b32 v4, 16, v68
    v_and_b32 v5, 0xffff0000, v68
    v_fma_f32 v40, v4, v108, v40
    v_fma_f32 v41, v5, v108, v41
    s_waitcnt vmcnt(30) lgkmcnt(0)
    v_lshlrev_b32 v4, 16, v69
    v_and_b32 v5, 0xffff0000, v69
    v_fma_f32 v40, v4, v109, v40
    v_fma_f32 v41, v5, v109, v41
    s_waitcnt vmcnt(29) lgkmcnt(0)
    v_lshlrev_b32 v4, 16, v70
    v_and_b32 v5, 0xffff0000, v70
    v_fma_f32 v40, v4, v110, v40
    v_fma_f32 v41, v5, v110, v41
    s_waitcnt vmcnt(28) lgkmcnt(0)
    v_lshlrev_b32 v4, 16, v71
    v_and_b32 v5, 0xffff0000, v71
    v_fma_f32 v40, v4, v111, v40
    v_fma_f32 v41, v5, v111, v41
    s_waitcnt vmcnt(27) lgkmcnt(0)
    v_lshlrev_b32 v4, 16, v72
    v_and_b32 v5, 0xffff0000, v72
    v_fma_f32 v40, v4, v112, v40
    v_fma_f32 v41, v5, v112, v41
    s_waitcnt vmcnt(26) lgkmcnt(0)
    v_lshlrev_b32 v4, 16, v73
    v_and_b32 v5, 0xffff0000, v73
    v_fma_f32 v40, v4, v113, v40
    v_fma_f32 v41, v5, v113, v41
    s_waitcnt vmcnt(25) lgkmcnt(0)
    v_lshlrev_b32 v4, 16, v74
    v_and_b32 v5, 0xffff0000, v74
    v_fma_f32 v40, v4, v114, v40
    v_fma_f32 v41, v5, v114, v41
    s_waitcnt vmcnt(24) lgkmcnt(0)
    v_lshlrev_b32 v4, 16, v75
    v_and_b32 v5, 0xffff0000, v75
    v_fma_f32 v40, v4, v115, v40
    v_fma_f32 v41, v5, v115, v41
    s_waitcnt vmcnt(23) lgkmcnt(0)
    v_lshlrev_b32 v4, 16, v76
    v_and_b32 v5, 0xffff0000, v76
    v_fma_f32 v40, v4, v116, v40
    v_fma_f32 v41, v5, v116, v41
    s_waitcnt vmcnt(22) lgkmcnt(0)
    v_lshlrev_b32 v4, 16, v77
    v_and_b32 v5, 0xffff0000, v77
    v_fma_f32 v40, v4, v117, v40
    v_fma_f32 v41, v5, v117, v41
    s_waitcnt vmcnt(21) lgkmcnt(0)
    v_lshlrev_b32 v4, 16, v78
    v_and_b32 v5, 0xffff0000, v78
    v_fma_f32 v40, v4, v118, v40
    v_fma_f32 v41, v5, v118, v41
    s_waitcnt vmcnt(20) lgkmcnt(0)
    v_lshlrev_b32 v4, 16, v79
    v_and_b32 v5, 0xffff0000, v79
    v_fma_f32 v40, v4, v119, v40
    v_fma_f32 v41, v5, v119, v41
    s_waitcnt vmcnt(19) lgkmcnt(0)
    v_lshlrev_b32 v4, 16, v80
    v_and_b32 v5, 0xffff0000, v80
    v_fma_f32 v40, v4, v120, v40
    v_fma_f32 v41, v5, v120, v41
    s_waitcnt vmcnt(18) lgkmcnt(0)
    v_lshlrev_b32 v4, 16, v81
    v_and_b32 v5, 0xffff0000, v81
    v_fma_f32 v40, v4, v121, v40
    v_fma_f32 v41, v5, v121, v41
    s_waitcnt vmcnt(17) lgkmcnt(0)
    v_lshlrev_b32 v4, 16, v82
    v_and_b32 v5, 0xffff0000, v82
    v_fma_f32 v40, v4, v122, v40
    v_fma_f32 v41, v5, v122, v41
    s_waitcnt vmcnt(16) lgkmcnt(0)
    v_lshlrev_b32 v4, 16, v83
    v_and_b32 v5, 0xffff0000, v83
    v_fma_f32 v40, v4, v123, v40
    v_fma_f32 v41, v5, v123, v41
    s_waitcnt vmcnt(15) lgkmcnt(0)
    v_lshlrev_b32 v4, 16, v84
    v_and_b32 v5, 0xffff0000, v84
    v_fma_f32 v40, v4, v124, v40
    v_fma_f32 v41, v5, v124, v41
    s_waitcnt vmcnt(14) lgkmcnt(0)
    v_lshlrev_b32 v4, 16, v85
    v_and_b32 v5, 0xffff0000, v85
    v_fma_f32 v40, v4, v125, v40
    v_fma_f32 v41, v5, v125, v41
    s_waitcnt vmcnt(13) lgkmcnt(0)
    v_lshlrev_b32 v4, 16, v86
    v_and_b32 v5, 0xffff0000, v86
    v_fma_f32 v40, v4, v126, v40
    v_fma_f32 v41, v5, v126, v41
    s_waitcnt vmcnt(12) lgkmcnt(0)
    v_lshlrev_b32 v4, 16, v87
    v_and_b32 v5, 0xffff0000, v87
    v_fma_f32 v40, v4, v127, v40
    v_fma_f32 v41, v5, v127, v41
    s_waitcnt vmcnt(11) lgkmcnt(0)
    v_lshlrev_b32 v4, 16, v88
    v_and_b32 v5, 0xffff0000, v88
    v_fma_f32 v40, v4, v128, v40
    v_fma_f32 v41, v5, v128, v41
    s_waitcnt vmcnt(10) lgkmcnt(0)
    v_lshlrev_b32 v4, 16, v89
    v_and_b32 v5, 0xffff0000, v89
    v_fma_f32 v40, v4, v129, v40
    v_fma_f32 v41, v5, v129, v41
    s_waitcnt vmcnt(9) lgkmcnt(0)
    v_lshlrev_b32 v4, 16, v90
    v_and_b32 v5, 0xffff0000, v90
    v_fma_f32 v40, v4, v130, v40
    v_fma_f32 v41, v5, v130, v41
    s_waitcnt vmcnt(8) lgkmcnt(0)
    v_lshlrev_b32 v4, 16, v91
    v_and_b32 v5, 0xffff0000, v91
    v_fma_f32 v40, v4, v131, v40
    v_fma_f32 v41, v5, v131, v41
    s_waitcnt vmcnt(7) lgkmcnt(0)
    v_lshlrev_b32 v4, 16, v92
    v_and_b32 v5, 0xffff0000, v92
    v_fma_f32 v40, v4, v132, v40
    v_fma_f32 v41, v5, v132, v41
    s_waitcnt vmcnt(6) lgkmcnt(0)
    v_lshlrev_b32 v4, 16, v93
    v_and_b32 v5, 0xffff0000, v93
    v_fma_f32 v40, v4, v133, v40
    v_fma_f32 v41, v5, v133, v41
    s_waitcnt vmcnt(5) lgkmcnt(0)
    v_lshlrev_b32 v4, 16, v94
    v_and_b32 v5, 0xffff0000, v94
    v_fma_f32 v40, v4, v134, v40
    v_fma_f32 v41, v5, v134, v41
    s_waitcnt vmcnt(4) lgkmcnt(0)
    v_lshlrev_b32 v4, 16, v95
    v_and_b32 v5, 0xffff0000, v95
    v_fma_f32 v40, v4, v135, v40
    v_fma_f32 v41, v5, v135, v41
    s_waitcnt vmcnt(3) lgkmcnt(0)
    v_lshlrev_b32 v4, 16, v96
    v_and_b32 v5, 0xffff0000, v96
    v_fma_f32 v40, v4, v136, v40
    v_fma_f32 v41, v5, v136, v41
    s_waitcnt vmcnt(2) lgkmcnt(0)
    v_lshlrev_b32 v4, 16, v97
    v_and_b32 v5, 0xffff0000, v97
    v_fma_f32 v40, v4, v137, v40
    v_fma_f32 v41, v5, v137, v41
    s_waitcnt vmcnt(1) lgkmcnt(0)
    v_lshlrev_b32 v4, 16, v98
    v_and_b32 v5, 0xffff0000, v98
    v_fma_f32 v40, v4, v138, v40
    v_fma_f32 v41, v5, v138, v41
    s_waitcnt vmcnt(0) lgkmcnt(0)
    v_lshlrev_b32 v4, 16, v99
    v_and_b32 v5, 0xffff0000, v99
    v_fma_f32 v40, v4, v139, v40
    v_fma_f32 v41, v5, v139, v41
    s_add_u32 s27, s27, 1
    s_cmp_lt_u32 s27, 4
    s_cbranch_scc1 .prep_mloop
    s_lshl_b32 s24, s23, 9
    v_lshlrev_b32 v1, 3, v1
    v_add_u32 v1, s24, v1
    ds_write_b64 v1, v[40:41] offset:4096
    s_waitcnt lgkmcnt(0)
    s_barrier
    v_cmp_gt_u32 vcc, 128, v0
    s_and_saveexec_b64 s[30:31], vcc
    s_cbranch_execz .prep_done
    v_lshlrev_b32 v1, 2, v0
    ds_read_b32 v2, v1 offset:4096
    ds_read_b32 v3, v1 offset:4608
    ds_read_b32 v4, v1 offset:5120
    ds_read_b32 v5, v1 offset:5632
    s_waitcnt lgkmcnt(0)
    v_add_f32 v2, v2, v3
    v_add_f32 v4, v4, v5
    v_add_f32 v2, v2, v4
    v_cvt_pk_bf16_f32 v2, v2, v2
    v_lshlrev_b32 v2, 16, v2
    s_lshl_b32 s24, s22, 9
    v_add_u32 v1, s24, v1
    global_store_dword v1, v2, s[20:21]

.prep_done:
    s_endpgm
.prep_ln1:
    s_sub_u32 s2, s2, 670
    s_load_dwordx2 s[4:5], s[0:1], 0
    s_load_dwordx2 s[6:7], s[0:1], 136
    v_lshrrev_b32 v1, 6, v0
    s_nop 0
    v_readfirstlane_b32 s23, v1
    v_and_b32 v1, 63, v0
    v_mul_u32_u24 v2, 20, v1
    s_lshl_b32 s8, s2, 4
    s_lshl_b32 s9, s23, 2
    s_add_u32 s8, s8, s9
    s_mul_i32 s8, s8, 1280
    v_add_u32 v2, s8, v2
    v_lshlrev_b32 v3, 1, v2
    v_mul_u32_u24 v4, 40, v1
    v_lshlrev_b32 v5, 2, v1
    s_waitcnt lgkmcnt(0)

    global_load_dwordx4 v[8:11], v2, s[4:5]
    global_load_dword v12, v2, s[4:5] offset:16
    v_add_u32 v2, 1280, v2
    global_load_dwordx4 v[14:17], v2, s[4:5]
    global_load_dword v18, v2, s[4:5] offset:16
    v_add_u32 v2, 1280, v2
    global_load_dwordx4 v[20:23], v2, s[4:5]
    global_load_dword v24, v2, s[4:5] offset:16
    v_add_u32 v2, 1280, v2
    global_load_dwordx4 v[26:29], v2, s[4:5]
    global_load_dword v30, v2, s[4:5] offset:16
    s_waitcnt vmcnt(0)
    v_lshlrev_b32 v40, 16, v8
    v_and_b32 v41, 0xffff0000, v8
    v_lshlrev_b32 v42, 16, v9
    v_and_b32 v43, 0xffff0000, v9
    v_lshlrev_b32 v44, 16, v10
    v_and_b32 v45, 0xffff0000, v10
    v_lshlrev_b32 v46, 16, v11
    v_and_b32 v47, 0xffff0000, v11
    v_lshlrev_b32 v48, 16, v12
    v_and_b32 v49, 0xffff0000, v12
    v_lshlrev_b32 v50, 16, v14
    v_and_b32 v51, 0xffff0000, v14
    v_lshlrev_b32 v52, 16, v15
    v_and_b32 v53, 0xffff0000, v15
    v_lshlrev_b32 v54, 16, v16
    v_and_b32 v55, 0xffff0000, v16
    v_lshlrev_b32 v56, 16, v17
    v_and_b32 v57, 0xffff0000, v17
    v_lshlrev_b32 v58, 16, v18
    v_and_b32 v59, 0xffff0000, v18
    v_lshlrev_b32 v60, 16, v20
    v_and_b32 v61, 0xffff0000, v20
    v_lshlrev_b32 v62, 16, v21
    v_and_b32 v63, 0xffff0000, v21
    v_lshlrev_b32 v64, 16, v22
    v_and_b32 v65, 0xffff0000, v22
    v_lshlrev_b32 v66, 16, v23
    v_and_b32 v67, 0xffff0000, v23
    v_lshlrev_b32 v68, 16, v24
    v_and_b32 v69, 0xffff0000, v24
    v_lshlrev_b32 v70, 16, v26
    v_and_b32 v71, 0xffff0000, v26
    v_lshlrev_b32 v72, 16, v27
    v_and_b32 v73, 0xffff0000, v27
    v_lshlrev_b32 v74, 16, v28
    v_and_b32 v75, 0xffff0000, v28
    v_lshlrev_b32 v76, 16, v29
    v_and_b32 v77, 0xffff0000, v29
    v_lshlrev_b32 v78, 16, v30
    v_and_b32 v79, 0xffff0000, v30
    v_add_f32 v28, v40, v41
    v_add_f32 v28, v28, v42
    v_add_f32 v28, v28, v43
    v_add_f32 v28, v28, v44
    v_add_f32 v28, v28, v45
    v_add_f32 v28, v28, v46
    v_add_f32 v28, v28, v47
    v_add_f32 v28, v28, v48
    v_add_f32 v28, v28, v49
    v_add_f32 v29, v50, v51
    v_add_f32 v29, v29, v52
    v_add_f32 v29, v29, v53
    v_add_f32 v29, v29, v54
    v_add_f32 v29, v29, v55
    v_add_f32 v29, v29, v56
    v_add_f32 v29, v29, v57
    v_add_f32 v29, v29, v58
    v_add_f32 v29, v29, v59
    v_add_f32 v30, v60, v61
    v_add_f32 v30, v30, v62
    v_add_f32 v30, v30, v63
    v_add_f32 v30, v30, v64
    v_add_f32 v30, v30, v65
    v_add_f32 v30, v30, v66
    v_add_f32 v30, v30, v67
    v_add_f32 v30, v30, v68
    v_add_f32 v30, v30, v69
    v_add_f32 v31, v70, v71
    v_add_f32 v31, v31, v72
    v_add_f32 v31, v31, v73
    v_add_f32 v31, v31, v74
    v_add_f32 v31, v31, v75
    v_add_f32 v31, v31, v76
    v_add_f32 v31, v31, v77
    v_add_f32 v31, v31, v78
    v_add_f32 v31, v31, v79
    v_xor_b32 v32, 4, v5
    ds_bpermute_b32 v33, v32, v28
    ds_bpermute_b32 v34, v32, v29
    ds_bpermute_b32 v35, v32, v30
    ds_bpermute_b32 v36, v32, v31
    s_waitcnt lgkmcnt(0)
    v_add_f32 v28, v28, v33
    v_add_f32 v29, v29, v34
    v_add_f32 v30, v30, v35
    v_add_f32 v31, v31, v36
    v_xor_b32 v32, 8, v5
    ds_bpermute_b32 v33, v32, v28
    ds_bpermute_b32 v34, v32, v29
    ds_bpermute_b32 v35, v32, v30
    ds_bpermute_b32 v36, v32, v31
    s_waitcnt lgkmcnt(0)
    v_add_f32 v28, v28, v33
    v_add_f32 v29, v29, v34
    v_add_f32 v30, v30, v35
    v_add_f32 v31, v31, v36
    v_xor_b32 v32, 16, v5
    ds_bpermute_b32 v33, v32, v28
    ds_bpermute_b32 v34, v32, v29
    ds_bpermute_b32 v35, v32, v30
    ds_bpermute_b32 v36, v32, v31
    s_waitcnt lgkmcnt(0)
    v_add_f32 v28, v28, v33
    v_add_f32 v29, v29, v34
    v_add_f32 v30, v30, v35
    v_add_f32 v31, v31, v36
    v_xor_b32 v32, 32, v5
    ds_bpermute_b32 v33, v32, v28
    ds_bpermute_b32 v34, v32, v29
    ds_bpermute_b32 v35, v32, v30
    ds_bpermute_b32 v36, v32, v31
    s_waitcnt lgkmcnt(0)
    v_add_f32 v28, v28, v33
    v_add_f32 v29, v29, v34
    v_add_f32 v30, v30, v35
    v_add_f32 v31, v31, v36
    v_xor_b32 v32, 64, v5
    ds_bpermute_b32 v33, v32, v28
    ds_bpermute_b32 v34, v32, v29
    ds_bpermute_b32 v35, v32, v30
    ds_bpermute_b32 v36, v32, v31
    s_waitcnt lgkmcnt(0)
    v_add_f32 v28, v28, v33
    v_add_f32 v29, v29, v34
    v_add_f32 v30, v30, v35
    v_add_f32 v31, v31, v36
    v_xor_b32 v32, 128, v5
    ds_bpermute_b32 v33, v32, v28
    ds_bpermute_b32 v34, v32, v29
    ds_bpermute_b32 v35, v32, v30
    ds_bpermute_b32 v36, v32, v31
    s_waitcnt lgkmcnt(0)
    v_add_f32 v28, v28, v33
    v_add_f32 v29, v29, v34
    v_add_f32 v30, v30, v35
    v_add_f32 v31, v31, v36
    v_mul_f32 v28, 0x3acccccd, v28
    v_sub_f32 v40, v40, v28
    v_sub_f32 v41, v41, v28
    v_sub_f32 v42, v42, v28
    v_sub_f32 v43, v43, v28
    v_sub_f32 v44, v44, v28
    v_sub_f32 v45, v45, v28
    v_sub_f32 v46, v46, v28
    v_sub_f32 v47, v47, v28
    v_sub_f32 v48, v48, v28
    v_sub_f32 v49, v49, v28
    v_mul_f32 v29, 0x3acccccd, v29
    v_sub_f32 v50, v50, v29
    v_sub_f32 v51, v51, v29
    v_sub_f32 v52, v52, v29
    v_sub_f32 v53, v53, v29
    v_sub_f32 v54, v54, v29
    v_sub_f32 v55, v55, v29
    v_sub_f32 v56, v56, v29
    v_sub_f32 v57, v57, v29
    v_sub_f32 v58, v58, v29
    v_sub_f32 v59, v59, v29
    v_mul_f32 v30, 0x3acccccd, v30
    v_sub_f32 v60, v60, v30
    v_sub_f32 v61, v61, v30
    v_sub_f32 v62, v62, v30
    v_sub_f32 v63, v63, v30
    v_sub_f32 v64, v64, v30
    v_sub_f32 v65, v65, v30
    v_sub_f32 v66, v66, v30
    v_sub_f32 v67, v67, v30
    v_sub_f32 v68, v68, v30
    v_sub_f32 v69, v69, v30
    v_mul_f32 v31, 0x3acccccd, v31
    v_sub_f32 v70, v70, v31
    v_sub_f32 v71, v71, v31
    v_sub_f32 v72, v72, v31
    v_sub_f32 v73, v73, v31
    v_sub_f32 v74, v74, v31
    v_sub_f32 v75, v75, v31
    v_sub_f32 v76, v76, v31
    v_sub_f32 v77, v77, v31
    v_sub_f32 v78, v78, v31
    v_sub_f32 v79, v79, v31
    v_mul_f32 v28, v40, v40
    v_fma_f32 v28, v41, v41, v28
    v_fma_f32 v28, v42, v42, v28
    v_fma_f32 v28, v43, v43, v28
    v_fma_f32 v28, v44, v44, v28
    v_fma_f32 v28, v45, v45, v28
    v_fma_f32 v28, v46, v46, v28
    v_fma_f32 v28, v47, v47, v28
    v_fma_f32 v28, v48, v48, v28
    v_fma_f32 v28, v49, v49, v28
    v_mul_f32 v29, v50, v50
    v_fma_f32 v29, v51, v51, v29
    v_fma_f32 v29, v52, v52, v29
    v_fma_f32 v29, v53, v53, v29
    v_fma_f32 v29, v54, v54, v29
    v_fma_f32 v29, v55, v55, v29
    v_fma_f32 v29, v56, v56, v29
    v_fma_f32 v29, v57, v57, v29
    v_fma_f32 v29, v58, v58, v29
    v_fma_f32 v29, v59, v59, v29
    v_mul_f32 v30, v60, v60
    v_fma_f32 v30, v61, v61, v30
    v_fma_f32 v30, v62, v62, v30
    v_fma_f32 v30, v63, v63, v30
    v_fma_f32 v30, v64, v64, v30
    v_fma_f32 v30, v65, v65, v30
    v_fma_f32 v30, v66, v66, v30
    v_fma_f32 v30, v67, v67, v30
    v_fma_f32 v30, v68, v68, v30
    v_fma_f32 v30, v69, v69, v30
    v_mul_f32 v31, v70, v70
    v_fma_f32 v31, v71, v71, v31
    v_fma_f32 v31, v72, v72, v31
    v_fma_f32 v31, v73, v73, v31
    v_fma_f32 v31, v74, v74, v31
    v_fma_f32 v31, v75, v75, v31
    v_fma_f32 v31, v76, v76, v31
    v_fma_f32 v31, v77, v77, v31
    v_fma_f32 v31, v78, v78, v31
    v_fma_f32 v31, v79, v79, v31
    v_xor_b32 v32, 4, v5
    ds_bpermute_b32 v33, v32, v28
    ds_bpermute_b32 v34, v32, v29
    ds_bpermute_b32 v35, v32, v30
    ds_bpermute_b32 v36, v32, v31
    s_waitcnt lgkmcnt(0)
    v_add_f32 v28, v28, v33
    v_add_f32 v29, v29, v34
    v_add_f32 v30, v30, v35
    v_add_f32 v31, v31, v36
    v_xor_b32 v32, 8, v5
    ds_bpermute_b32 v33, v32, v28
    ds_bpermute_b32 v34, v32, v29
    ds_bpermute_b32 v35, v32, v30
    ds_bpermute_b32 v36, v32, v31
    s_waitcnt lgkmcnt(0)
    v_add_f32 v28, v28, v33
    v_add_f32 v29, v29, v34
    v_add_f32 v30, v30, v35
    v_add_f32 v31, v31, v36
    v_xor_b32 v32, 16, v5
    ds_bpermute_b32 v33, v32, v28
    ds_bpermute_b32 v34, v32, v29
    ds_bpermute_b32 v35, v32, v30
    ds_bpermute_b32 v36, v32, v31
    s_waitcnt lgkmcnt(0)
    v_add_f32 v28, v28, v33
    v_add_f32 v29, v29, v34
    v_add_f32 v30, v30, v35
    v_add_f32 v31, v31, v36
    v_xor_b32 v32, 32, v5
    ds_bpermute_b32 v33, v32, v28
    ds_bpermute_b32 v34, v32, v29
    ds_bpermute_b32 v35, v32, v30
    ds_bpermute_b32 v36, v32, v31
    s_waitcnt lgkmcnt(0)
    v_add_f32 v28, v28, v33
    v_add_f32 v29, v29, v34
    v_add_f32 v30, v30, v35
    v_add_f32 v31, v31, v36
    v_xor_b32 v32, 64, v5
    ds_bpermute_b32 v33, v32, v28
    ds_bpermute_b32 v34, v32, v29
    ds_bpermute_b32 v35, v32, v30
    ds_bpermute_b32 v36, v32, v31
    s_waitcnt lgkmcnt(0)
    v_add_f32 v28, v28, v33
    v_add_f32 v29, v29, v34
    v_add_f32 v30, v30, v35
    v_add_f32 v31, v31, v36
    v_xor_b32 v32, 128, v5
    ds_bpermute_b32 v33, v32, v28
    ds_bpermute_b32 v34, v32, v29
    ds_bpermute_b32 v35, v32, v30
    ds_bpermute_b32 v36, v32, v31
    s_waitcnt lgkmcnt(0)
    v_add_f32 v28, v28, v33
    v_add_f32 v29, v29, v34
    v_add_f32 v30, v30, v35
    v_add_f32 v31, v31, v36
    v_mul_f32 v28, 0x3acccccd, v28
    v_add_f32 v28, 0x3727c5ac, v28
    v_rsq_f32 v28, v28
    s_nop 0
    v_mul_f32 v40, v40, v28
    v_mul_f32 v41, v41, v28
    v_mul_f32 v42, v42, v28
    v_mul_f32 v43, v43, v28
    v_mul_f32 v44, v44, v28
    v_mul_f32 v45, v45, v28
    v_mul_f32 v46, v46, v28
    v_mul_f32 v47, v47, v28
    v_mul_f32 v48, v48, v28
    v_mul_f32 v49, v49, v28
    v_mul_f32 v29, 0x3acccccd, v29
    v_add_f32 v29, 0x3727c5ac, v29
    v_rsq_f32 v29, v29
    s_nop 0
    v_mul_f32 v50, v50, v29
    v_mul_f32 v51, v51, v29
    v_mul_f32 v52, v52, v29
    v_mul_f32 v53, v53, v29
    v_mul_f32 v54, v54, v29
    v_mul_f32 v55, v55, v29
    v_mul_f32 v56, v56, v29
    v_mul_f32 v57, v57, v29
    v_mul_f32 v58, v58, v29
    v_mul_f32 v59, v59, v29
    v_mul_f32 v30, 0x3acccccd, v30
    v_add_f32 v30, 0x3727c5ac, v30
    v_rsq_f32 v30, v30
    s_nop 0
    v_mul_f32 v60, v60, v30
    v_mul_f32 v61, v61, v30
    v_mul_f32 v62, v62, v30
    v_mul_f32 v63, v63, v30
    v_mul_f32 v64, v64, v30
    v_mul_f32 v65, v65, v30
    v_mul_f32 v66, v66, v30
    v_mul_f32 v67, v67, v30
    v_mul_f32 v68, v68, v30
    v_mul_f32 v69, v69, v30
    v_mul_f32 v31, 0x3acccccd, v31
    v_add_f32 v31, 0x3727c5ac, v31
    v_rsq_f32 v31, v31
    s_nop 0
    v_mul_f32 v70, v70, v31
    v_mul_f32 v71, v71, v31
    v_mul_f32 v72, v72, v31
    v_mul_f32 v73, v73, v31
    v_mul_f32 v74, v74, v31
    v_mul_f32 v75, v75, v31
    v_mul_f32 v76, v76, v31
    v_mul_f32 v77, v77, v31
    v_mul_f32 v78, v78, v31
    v_mul_f32 v79, v79, v31
    v_mul_u32_u24 v6, 320, v1
    s_lshl_b32 s9, s23, 3
    v_add_u32 v6, s9, v6

    v_cvt_pk_bf16_f32 v8, v40, v50
    v_cvt_pk_bf16_f32 v9, v60, v70
    ds_write_b64 v6, v[8:9] offset:0
    v_cvt_pk_bf16_f32 v8, v41, v51
    v_cvt_pk_bf16_f32 v9, v61, v71
    ds_write_b64 v6, v[8:9] offset:32
    v_cvt_pk_bf16_f32 v8, v42, v52
    v_cvt_pk_bf16_f32 v9, v62, v72
    ds_write_b64 v6, v[8:9] offset:64
    v_cvt_pk_bf16_f32 v8, v43, v53
    v_cvt_pk_bf16_f32 v9, v63, v73
    ds_write_b64 v6, v[8:9] offset:96
    v_cvt_pk_bf16_f32 v8, v44, v54
    v_cvt_pk_bf16_f32 v9, v64, v74
    ds_write_b64 v6, v[8:9] offset:128
    v_cvt_pk_bf16_f32 v8, v45, v55
    v_cvt_pk_bf16_f32 v9, v65, v75
    ds_write_b64 v6, v[8:9] offset:160
    v_cvt_pk_bf16_f32 v8, v46, v56
    v_cvt_pk_bf16_f32 v9, v66, v76
    ds_write_b64 v6, v[8:9] offset:192
    v_cvt_pk_bf16_f32 v8, v47, v57
    v_cvt_pk_bf16_f32 v9, v67, v77
    ds_write_b64 v6, v[8:9] offset:224
    v_cvt_pk_bf16_f32 v8, v48, v58
    v_cvt_pk_bf16_f32 v9, v68, v78
    ds_write_b64 v6, v[8:9] offset:256
    v_cvt_pk_bf16_f32 v8, v49, v59
    v_cvt_pk_bf16_f32 v9, v69, v79
    ds_write_b64 v6, v[8:9] offset:288
    s_waitcnt lgkmcnt(0)
    s_barrier
    s_lshl_b32 s8, s2, 5
    s_add_u32 s8, s8, 3145728

    v_add_u32 v6, 0, v0
    v_lshlrev_b32 v7, 5, v6
    ds_read_b128 v[8:11], v7
    ds_read_b128 v[12:15], v7 offset:16
    v_lshlrev_b32 v7, 12, v6
    v_add_u32 v7, s8, v7
    s_waitcnt lgkmcnt(0)
    global_store_dwordx4 v7, v[8:11], s[6:7]
    global_store_dwordx4 v7, v[12:15], s[6:7] offset:16

    v_add_u32 v6, 256, v0
    v_lshlrev_b32 v7, 5, v6
    ds_read_b128 v[8:11], v7
    ds_read_b128 v[12:15], v7 offset:16
    v_lshlrev_b32 v7, 12, v6
    v_add_u32 v7, s8, v7
    s_waitcnt lgkmcnt(0)
    global_store_dwordx4 v7, v[8:11], s[6:7]
    global_store_dwordx4 v7, v[12:15], s[6:7] offset:16

    v_cmp_gt_u32 vcc, 128, v0
    s_and_saveexec_b64 s[10:11], vcc
    s_cbranch_execz .ln1_done

    v_add_u32 v6, 512, v0
    v_lshlrev_b32 v7, 5, v6
    ds_read_b128 v[8:11], v7
    ds_read_b128 v[12:15], v7 offset:16
    v_lshlrev_b32 v7, 12, v6
    v_add_u32 v7, s8, v7
    s_waitcnt lgkmcnt(0)
    global_store_dwordx4 v7, v[8:11], s[6:7]
    global_store_dwordx4 v7, v[12:15], s[6:7] offset:16

.ln1_done:
    s_endpgm
.globl conv_kernel
.p2align 8
.type conv_kernel,@function
conv_kernel:
    s_cmp_ge_u32 s2, 640
    s_cbranch_scc1 .conv_done
    s_load_dwordx2 s[6:7], s[0:1], 136
    v_lshrrev_b32 v1, 6, v0
    s_nop 0
    v_readfirstlane_b32 s23, v1
    s_waitcnt lgkmcnt(0)
    s_lshl_b32 s8, s2, 12
    s_add_u32 s9, s8, 65536
    s_add_u32 s10, s8, 3145728
    v_lshlrev_b32 v1, 4, v0
    v_add_u32 v2, s9, v1
    v_add_u32 v3, s10, v1
    global_load_dwordx4 v[12:15], v2, s[6:7]
    global_load_dwordx4 v[16:19], v3, s[6:7]
    s_lshl_b32 s11, s2, 2
    v_mov_b32 v4, s11
    global_load_dword v24, v4, s[6:7]
    global_load_dword v25, v4, s[6:7] offset:2560
    v_subrev_u32 v2, 16, v2
    v_cmp_ne_u32 vcc, 0, v0
    s_and_saveexec_b64 s[12:13], vcc
    global_load_dwordx4 v[8:11], v2, s[6:7]
    s_mov_b64 exec, s[12:13]
    v_cmp_eq_u32 vcc, 0, v0
    s_waitcnt vmcnt(0)
    v_cndmask_b32 v8, v8, 0, vcc
    v_cndmask_b32 v9, v9, 0, vcc
    v_cndmask_b32 v10, v10, 0, vcc
    v_cndmask_b32 v11, v11, 0, vcc
    s_mov_b32 s14, 0x03020504
    v_add_f32 v25, 1.0, v25
    v_cvt_pk_bf16_f32 v25, v25, v25
    v_lshlrev_b32 v25, 16, v25

    v_lshlrev_b32 v26, 16, v16
    v_and_b32 v27, 0xffff0000, v16
    v_fma_f32 v26, v26, v25, v24
    v_fma_f32 v27, v27, v25, v24
    v_cvt_pk_bf16_f32 v16, v26, v27

    v_lshlrev_b32 v26, 16, v17
    v_and_b32 v27, 0xffff0000, v17
    v_fma_f32 v26, v26, v25, v24
    v_fma_f32 v27, v27, v25, v24
    v_cvt_pk_bf16_f32 v17, v26, v27

    v_lshlrev_b32 v26, 16, v18
    v_and_b32 v27, 0xffff0000, v18
    v_fma_f32 v26, v26, v25, v24
    v_fma_f32 v27, v27, v25, v24
    v_cvt_pk_bf16_f32 v18, v26, v27

    v_lshlrev_b32 v26, 16, v19
    v_and_b32 v27, 0xffff0000, v19
    v_fma_f32 v26, v26, v25, v24
    v_fma_f32 v27, v27, v25, v24
    v_cvt_pk_bf16_f32 v19, v26, v27

    ds_write_b128 v1, v[16:19] offset:33792
    v_perm_b32 v20, v12, v11, s14
    v_perm_b32 v21, v11, v10, s14
    v_perm_b32 v22, v10, v9, s14
    v_perm_b32 v23, v9, v8, s14
    ds_write_b128 v1, v[20:23] offset:16
    s_nop 1
    v_alignbit_b32 v20, v12, v12, 16
    v_alignbit_b32 v21, v11, v11, 16
    v_alignbit_b32 v22, v10, v10, 16
    v_alignbit_b32 v23, v9, v9, 16
    ds_write_b128 v1, v[20:23] offset:4176
    s_nop 1
    v_perm_b32 v20, v13, v12, s14
    v_perm_b32 v21, v12, v11, s14
    v_perm_b32 v22, v11, v10, s14
    v_perm_b32 v23, v10, v9, s14
    ds_write_b128 v1, v[20:23] offset:8336
    s_nop 1
    v_alignbit_b32 v20, v13, v13, 16
    v_alignbit_b32 v21, v12, v12, 16
    v_alignbit_b32 v22, v11, v11, 16
    v_alignbit_b32 v23, v10, v10, 16
    ds_write_b128 v1, v[20:23] offset:12496
    s_nop 1
    v_perm_b32 v20, v14, v13, s14
    v_perm_b32 v21, v13, v12, s14
    v_perm_b32 v22, v12, v11, s14
    v_perm_b32 v23, v11, v10, s14
    ds_write_b128 v1, v[20:23] offset:16656
    s_nop 1
    v_alignbit_b32 v20, v14, v14, 16
    v_alignbit_b32 v21, v13, v13, 16
    v_alignbit_b32 v22, v12, v12, 16
    v_alignbit_b32 v23, v11, v11, 16
    ds_write_b128 v1, v[20:23] offset:20816
    s_nop 1
    v_perm_b32 v20, v15, v14, s14
    v_perm_b32 v21, v14, v13, s14
    v_perm_b32 v22, v13, v12, s14
    v_perm_b32 v23, v12, v11, s14
    ds_write_b128 v1, v[20:23] offset:24976
    s_nop 1
    v_alignbit_b32 v20, v15, v15, 16
    v_alignbit_b32 v21, v14, v14, 16
    v_alignbit_b32 v22, v13, v13, 16
    v_alignbit_b32 v23, v12, v12, 16
    ds_write_b128 v1, v[20:23] offset:29136
    s_nop 1
    v_mov_b32 v20, 0
    v_mov_b32 v21, 0
    v_mov_b32 v22, 0
    v_mov_b32 v23, 0
    v_cmp_gt_u32 vcc, 8, v0
    s_and_saveexec_b64 s[12:13], vcc
    v_mul_u32_u24 v2, 4160, v0
    ds_write_b128 v2, v[20:23]
    s_mov_b64 exec, s[12:13]
    v_cmp_gt_u32 vcc, 32, v0
    s_and_saveexec_b64 s[12:13], vcc
    ds_write_b128 v1, v[20:23] offset:33280
    s_mov_b64 exec, s[12:13]
    s_waitcnt lgkmcnt(0)
    s_barrier
    v_and_b32 v1, 15, v0
    v_bfe_u32 v2, v0, 4, 2
    v_and_b32 v3, 7, v1
    v_mul_u32_u24 v3, 4160, v3
    v_lshrrev_b32 v4, 1, v2
    v_lshlrev_b32 v4, 5, v4
    v_and_b32 v5, 1, v2
    v_lshlrev_b32 v5, 4, v5
    v_sub_u32 v4, v4, v5
    v_lshrrev_b32 v6, 3, v1
    v_lshlrev_b32 v6, 4, v6
    v_add_u32 v4, v4, v6
    v_add_u32 v4, 16, v4
    v_add_u32 v3, v3, v4
    v_lshrrev_b32 v4, 1, v2
    v_sub_u32 v4, v1, v4
    v_lshlrev_b32 v4, 5, v4
    v_add_u32 v4, v4, v5
    v_add_u32 v4, 33792, v4
    s_lshl_b32 s15, s23, 9
    v_add_u32 v6, s15, v4
    s_sub_u32 s16, 7, s23
    s_lshl_b32 s16, s16, 9
    v_add_u32 v7, s16, v4
    v_mov_b32 v40, 0
    v_mov_b32 v41, 0
    v_mov_b32 v42, 0
    v_mov_b32 v43, 0
    v_mov_b32 v44, 0
    v_mov_b32 v45, 0
    v_mov_b32 v46, 0
    v_mov_b32 v47, 0
    s_add_u32 s17, s23, 1
    s_lshl_b32 s17, s17, 3
    s_sub_u32 s18, 8, s23
    s_lshl_b32 s18, s18, 3
    s_mov_b32 s19, 0

.conv_l1:
    ds_read_b128 v[8:11], v3
    ds_read_b128 v[12:15], v6
    ds_read_b128 v[16:19], v7
    v_add_u32 v3, 64, v3
    v_subrev_u32 v6, 64, v6
    v_subrev_u32 v7, 64, v7
    s_waitcnt lgkmcnt(0)
    v_mfma_f32_16x16x32_bf16 v[40:43], v[8:11], v[12:15], v[40:43]
    v_mfma_f32_16x16x32_bf16 v[44:47], v[8:11], v[16:19], v[44:47]
    s_add_u32 s19, s19, 1
    s_cmp_lt_u32 s19, s17
    s_cbranch_scc1 .conv_l1

.conv_l2:
    s_cmp_ge_u32 s19, s18
    s_cbranch_scc1 .conv_ep
    ds_read_b128 v[8:11], v3
    ds_read_b128 v[16:19], v7
    v_add_u32 v3, 64, v3
    v_subrev_u32 v7, 64, v7
    s_waitcnt lgkmcnt(0)
    v_mfma_f32_16x16x32_bf16 v[44:47], v[8:11], v[16:19], v[44:47]
    s_add_u32 s19, s19, 1
    s_branch .conv_l2

.conv_ep:
    s_nop 7
    s_nop 7
    v_cvt_pk_bf16_f32 v8, v40, v41
    v_cvt_pk_bf16_f32 v9, v42, v43
    v_cvt_pk_bf16_f32 v10, v44, v45
    v_cvt_pk_bf16_f32 v11, v46, v47
    v_lshlrev_b32 v4, 5, v1
    v_lshlrev_b32 v5, 3, v2
    v_add_u32 v4, v4, v5
    s_lshl_b32 s8, s2, 12
    s_add_u32 s8, s8, 6291456
    v_add_u32 v4, s8, v4
    v_add_u32 v5, s15, v4
    v_add_u32 v6, s16, v4
    global_store_dwordx2 v5, v[8:9], s[6:7]
    global_store_dwordx2 v6, v[10:11], s[6:7]

.conv_done:
    s_endpgm
.globl ln2_kernel
.p2align 8
.type ln2_kernel,@function
ln2_kernel:
    s_cmp_ge_u32 s2, 128
    s_cbranch_scc1 .ln2_done
    s_load_dwordx2 s[4:5], s[0:1], 0
    s_load_dwordx2 s[6:7], s[0:1], 136
    v_lshrrev_b32 v1, 6, v0
    s_nop 0
    v_readfirstlane_b32 s23, v1
    s_waitcnt lgkmcnt(0)
    s_lshl_b32 s8, s2, 5
    s_add_u32 s8, s8, 6291456

    v_add_u32 v6, 0, v0
    v_lshlrev_b32 v7, 12, v6
    v_add_u32 v7, s8, v7
    global_load_dwordx4 v[8:11], v7, s[6:7]
    global_load_dwordx4 v[12:15], v7, s[6:7] offset:16
    v_lshlrev_b32 v7, 5, v6
    s_waitcnt vmcnt(0)
    ds_write_b128 v7, v[8:11]
    ds_write_b128 v7, v[12:15] offset:16

    v_add_u32 v6, 256, v0
    v_lshlrev_b32 v7, 12, v6
    v_add_u32 v7, s8, v7
    global_load_dwordx4 v[8:11], v7, s[6:7]
    global_load_dwordx4 v[12:15], v7, s[6:7] offset:16
    v_lshlrev_b32 v7, 5, v6
    s_waitcnt vmcnt(0)
    ds_write_b128 v7, v[8:11]
    ds_write_b128 v7, v[12:15] offset:16

    v_cmp_gt_u32 vcc, 128, v0
    s_and_saveexec_b64 s[10:11], vcc

    v_add_u32 v6, 512, v0
    v_lshlrev_b32 v7, 12, v6
    v_add_u32 v7, s8, v7
    global_load_dwordx4 v[8:11], v7, s[6:7]
    global_load_dwordx4 v[12:15], v7, s[6:7] offset:16
    v_lshlrev_b32 v7, 5, v6
    s_waitcnt vmcnt(0)
    ds_write_b128 v7, v[8:11]
    ds_write_b128 v7, v[12:15] offset:16

    s_mov_b64 exec, -1
    v_and_b32 v1, 63, v0
    v_mul_u32_u24 v2, 20, v1
    s_lshl_b32 s8, s2, 4
    s_lshl_b32 s9, s23, 2
    s_add_u32 s8, s8, s9
    s_mul_i32 s8, s8, 1280
    v_add_u32 v2, s8, v2
    v_mul_u32_u24 v4, 40, v1
    v_lshlrev_b32 v5, 2, v1
    v_mov_b32 v3, v2

    global_load_dwordx4 v[8:11], v3, s[4:5]
    global_load_dword v12, v3, s[4:5] offset:16
    v_add_u32 v3, 1280, v3
    global_load_dwordx4 v[14:17], v3, s[4:5]
    global_load_dword v18, v3, s[4:5] offset:16
    v_add_u32 v3, 1280, v3
    global_load_dwordx4 v[20:23], v3, s[4:5]
    global_load_dword v24, v3, s[4:5] offset:16
    v_add_u32 v3, 1280, v3
    global_load_dwordx4 v[26:29], v3, s[4:5]
    global_load_dword v30, v3, s[4:5] offset:16
    v_add_u32 v37, 5120, v4
    global_load_dwordx4 v[80:83], v37, s[6:7] offset:0
    global_load_dwordx4 v[84:87], v37, s[6:7] offset:16
    global_load_dwordx2 v[88:89], v37, s[6:7] offset:32
    v_add_u32 v37, 7680, v4
    global_load_dwordx4 v[90:93], v37, s[6:7] offset:0
    global_load_dwordx4 v[94:97], v37, s[6:7] offset:16
    global_load_dwordx2 v[98:99], v37, s[6:7] offset:32
    v_add_u32 v37, 10240, v4
    global_load_dwordx4 v[100:103], v37, s[6:7] offset:0
    global_load_dwordx4 v[104:107], v37, s[6:7] offset:16
    global_load_dwordx2 v[108:109], v37, s[6:7] offset:32
    s_waitcnt lgkmcnt(0)
    s_barrier
    v_mul_u32_u24 v6, 320, v1
    s_lshl_b32 s9, s23, 3
    v_add_u32 v6, s9, v6

    ds_read_b64 v[110:111], v6 offset:0
    ds_read_b64 v[112:113], v6 offset:32
    ds_read_b64 v[114:115], v6 offset:64
    ds_read_b64 v[116:117], v6 offset:96
    ds_read_b64 v[118:119], v6 offset:128
    ds_read_b64 v[120:121], v6 offset:160
    ds_read_b64 v[122:123], v6 offset:192
    ds_read_b64 v[124:125], v6 offset:224
    ds_read_b64 v[126:127], v6 offset:256
    ds_read_b64 v[128:129], v6 offset:288
    s_waitcnt vmcnt(0) lgkmcnt(0)
    v_lshlrev_b32 v40, 16, v8
    v_and_b32 v41, 0xffff0000, v8
    v_lshlrev_b32 v42, 16, v9
    v_and_b32 v43, 0xffff0000, v9
    v_lshlrev_b32 v44, 16, v10
    v_and_b32 v45, 0xffff0000, v10
    v_lshlrev_b32 v46, 16, v11
    v_and_b32 v47, 0xffff0000, v11
    v_lshlrev_b32 v48, 16, v12
    v_and_b32 v49, 0xffff0000, v12
    v_lshlrev_b32 v50, 16, v14
    v_and_b32 v51, 0xffff0000, v14
    v_lshlrev_b32 v52, 16, v15
    v_and_b32 v53, 0xffff0000, v15
    v_lshlrev_b32 v54, 16, v16
    v_and_b32 v55, 0xffff0000, v16
    v_lshlrev_b32 v56, 16, v17
    v_and_b32 v57, 0xffff0000, v17
    v_lshlrev_b32 v58, 16, v18
    v_and_b32 v59, 0xffff0000, v18
    v_lshlrev_b32 v60, 16, v20
    v_and_b32 v61, 0xffff0000, v20
    v_lshlrev_b32 v62, 16, v21
    v_and_b32 v63, 0xffff0000, v21
    v_lshlrev_b32 v64, 16, v22
    v_and_b32 v65, 0xffff0000, v22
    v_lshlrev_b32 v66, 16, v23
    v_and_b32 v67, 0xffff0000, v23
    v_lshlrev_b32 v68, 16, v24
    v_and_b32 v69, 0xffff0000, v24
    v_lshlrev_b32 v70, 16, v26
    v_and_b32 v71, 0xffff0000, v26
    v_lshlrev_b32 v72, 16, v27
    v_and_b32 v73, 0xffff0000, v27
    v_lshlrev_b32 v74, 16, v28
    v_and_b32 v75, 0xffff0000, v28
    v_lshlrev_b32 v76, 16, v29
    v_and_b32 v77, 0xffff0000, v29
    v_lshlrev_b32 v78, 16, v30
    v_and_b32 v79, 0xffff0000, v30
    v_lshlrev_b32 v6, 16, v110
    v_mul_f32 v6, v6, v80
    v_cvt_pk_bf16_f32 v6, v6, v6
    v_lshlrev_b32 v6, 16, v6
    v_add_f32 v6, v6, v40
    v_cvt_pk_bf16_f32 v6, v6, v6
    v_lshlrev_b32 v40, 16, v6
    v_and_b32 v6, 0xffff0000, v110
    v_mul_f32 v6, v6, v80
    v_cvt_pk_bf16_f32 v6, v6, v6
    v_lshlrev_b32 v6, 16, v6
    v_add_f32 v6, v6, v50
    v_cvt_pk_bf16_f32 v6, v6, v6
    v_lshlrev_b32 v50, 16, v6
    v_lshlrev_b32 v6, 16, v111
    v_mul_f32 v6, v6, v80
    v_cvt_pk_bf16_f32 v6, v6, v6
    v_lshlrev_b32 v6, 16, v6
    v_add_f32 v6, v6, v60
    v_cvt_pk_bf16_f32 v6, v6, v6
    v_lshlrev_b32 v60, 16, v6
    v_and_b32 v6, 0xffff0000, v111
    v_mul_f32 v6, v6, v80
    v_cvt_pk_bf16_f32 v6, v6, v6
    v_lshlrev_b32 v6, 16, v6
    v_add_f32 v6, v6, v70
    v_cvt_pk_bf16_f32 v6, v6, v6
    v_lshlrev_b32 v70, 16, v6
    v_lshlrev_b32 v6, 16, v112
    v_mul_f32 v6, v6, v81
    v_cvt_pk_bf16_f32 v6, v6, v6
    v_lshlrev_b32 v6, 16, v6
    v_add_f32 v6, v6, v41
    v_cvt_pk_bf16_f32 v6, v6, v6
    v_lshlrev_b32 v41, 16, v6
    v_and_b32 v6, 0xffff0000, v112
    v_mul_f32 v6, v6, v81
    v_cvt_pk_bf16_f32 v6, v6, v6
    v_lshlrev_b32 v6, 16, v6
    v_add_f32 v6, v6, v51
    v_cvt_pk_bf16_f32 v6, v6, v6
    v_lshlrev_b32 v51, 16, v6
    v_lshlrev_b32 v6, 16, v113
    v_mul_f32 v6, v6, v81
    v_cvt_pk_bf16_f32 v6, v6, v6
    v_lshlrev_b32 v6, 16, v6
    v_add_f32 v6, v6, v61
    v_cvt_pk_bf16_f32 v6, v6, v6
    v_lshlrev_b32 v61, 16, v6
    v_and_b32 v6, 0xffff0000, v113
    v_mul_f32 v6, v6, v81
    v_cvt_pk_bf16_f32 v6, v6, v6
    v_lshlrev_b32 v6, 16, v6
    v_add_f32 v6, v6, v71
    v_cvt_pk_bf16_f32 v6, v6, v6
    v_lshlrev_b32 v71, 16, v6
    v_lshlrev_b32 v6, 16, v114
    v_mul_f32 v6, v6, v82
    v_cvt_pk_bf16_f32 v6, v6, v6
    v_lshlrev_b32 v6, 16, v6
    v_add_f32 v6, v6, v42
    v_cvt_pk_bf16_f32 v6, v6, v6
    v_lshlrev_b32 v42, 16, v6
    v_and_b32 v6, 0xffff0000, v114
    v_mul_f32 v6, v6, v82
    v_cvt_pk_bf16_f32 v6, v6, v6
    v_lshlrev_b32 v6, 16, v6
    v_add_f32 v6, v6, v52
    v_cvt_pk_bf16_f32 v6, v6, v6
    v_lshlrev_b32 v52, 16, v6
    v_lshlrev_b32 v6, 16, v115
    v_mul_f32 v6, v6, v82
    v_cvt_pk_bf16_f32 v6, v6, v6
    v_lshlrev_b32 v6, 16, v6
    v_add_f32 v6, v6, v62
    v_cvt_pk_bf16_f32 v6, v6, v6
    v_lshlrev_b32 v62, 16, v6
    v_and_b32 v6, 0xffff0000, v115
    v_mul_f32 v6, v6, v82
    v_cvt_pk_bf16_f32 v6, v6, v6
    v_lshlrev_b32 v6, 16, v6
    v_add_f32 v6, v6, v72
    v_cvt_pk_bf16_f32 v6, v6, v6
    v_lshlrev_b32 v72, 16, v6
    v_lshlrev_b32 v6, 16, v116
    v_mul_f32 v6, v6, v83
    v_cvt_pk_bf16_f32 v6, v6, v6
    v_lshlrev_b32 v6, 16, v6
    v_add_f32 v6, v6, v43
    v_cvt_pk_bf16_f32 v6, v6, v6
    v_lshlrev_b32 v43, 16, v6
    v_and_b32 v6, 0xffff0000, v116
    v_mul_f32 v6, v6, v83
    v_cvt_pk_bf16_f32 v6, v6, v6
    v_lshlrev_b32 v6, 16, v6
    v_add_f32 v6, v6, v53
    v_cvt_pk_bf16_f32 v6, v6, v6
    v_lshlrev_b32 v53, 16, v6
    v_lshlrev_b32 v6, 16, v117
    v_mul_f32 v6, v6, v83
    v_cvt_pk_bf16_f32 v6, v6, v6
    v_lshlrev_b32 v6, 16, v6
    v_add_f32 v6, v6, v63
    v_cvt_pk_bf16_f32 v6, v6, v6
    v_lshlrev_b32 v63, 16, v6
    v_and_b32 v6, 0xffff0000, v117
    v_mul_f32 v6, v6, v83
    v_cvt_pk_bf16_f32 v6, v6, v6
    v_lshlrev_b32 v6, 16, v6
    v_add_f32 v6, v6, v73
    v_cvt_pk_bf16_f32 v6, v6, v6
    v_lshlrev_b32 v73, 16, v6
    v_lshlrev_b32 v6, 16, v118
    v_mul_f32 v6, v6, v84
    v_cvt_pk_bf16_f32 v6, v6, v6
    v_lshlrev_b32 v6, 16, v6
    v_add_f32 v6, v6, v44
    v_cvt_pk_bf16_f32 v6, v6, v6
    v_lshlrev_b32 v44, 16, v6
    v_and_b32 v6, 0xffff0000, v118
    v_mul_f32 v6, v6, v84
    v_cvt_pk_bf16_f32 v6, v6, v6
    v_lshlrev_b32 v6, 16, v6
    v_add_f32 v6, v6, v54
    v_cvt_pk_bf16_f32 v6, v6, v6
    v_lshlrev_b32 v54, 16, v6
    v_lshlrev_b32 v6, 16, v119
    v_mul_f32 v6, v6, v84
    v_cvt_pk_bf16_f32 v6, v6, v6
    v_lshlrev_b32 v6, 16, v6
    v_add_f32 v6, v6, v64
    v_cvt_pk_bf16_f32 v6, v6, v6
    v_lshlrev_b32 v64, 16, v6
    v_and_b32 v6, 0xffff0000, v119
    v_mul_f32 v6, v6, v84
    v_cvt_pk_bf16_f32 v6, v6, v6
    v_lshlrev_b32 v6, 16, v6
    v_add_f32 v6, v6, v74
    v_cvt_pk_bf16_f32 v6, v6, v6
    v_lshlrev_b32 v74, 16, v6
    v_lshlrev_b32 v6, 16, v120
    v_mul_f32 v6, v6, v85
    v_cvt_pk_bf16_f32 v6, v6, v6
    v_lshlrev_b32 v6, 16, v6
    v_add_f32 v6, v6, v45
    v_cvt_pk_bf16_f32 v6, v6, v6
    v_lshlrev_b32 v45, 16, v6
    v_and_b32 v6, 0xffff0000, v120
    v_mul_f32 v6, v6, v85
    v_cvt_pk_bf16_f32 v6, v6, v6
    v_lshlrev_b32 v6, 16, v6
    v_add_f32 v6, v6, v55
    v_cvt_pk_bf16_f32 v6, v6, v6
    v_lshlrev_b32 v55, 16, v6
    v_lshlrev_b32 v6, 16, v121
    v_mul_f32 v6, v6, v85
    v_cvt_pk_bf16_f32 v6, v6, v6
    v_lshlrev_b32 v6, 16, v6
    v_add_f32 v6, v6, v65
    v_cvt_pk_bf16_f32 v6, v6, v6
    v_lshlrev_b32 v65, 16, v6
    v_and_b32 v6, 0xffff0000, v121
    v_mul_f32 v6, v6, v85
    v_cvt_pk_bf16_f32 v6, v6, v6
    v_lshlrev_b32 v6, 16, v6
    v_add_f32 v6, v6, v75
    v_cvt_pk_bf16_f32 v6, v6, v6
    v_lshlrev_b32 v75, 16, v6
    v_lshlrev_b32 v6, 16, v122
    v_mul_f32 v6, v6, v86
    v_cvt_pk_bf16_f32 v6, v6, v6
    v_lshlrev_b32 v6, 16, v6
    v_add_f32 v6, v6, v46
    v_cvt_pk_bf16_f32 v6, v6, v6
    v_lshlrev_b32 v46, 16, v6
    v_and_b32 v6, 0xffff0000, v122
    v_mul_f32 v6, v6, v86
    v_cvt_pk_bf16_f32 v6, v6, v6
    v_lshlrev_b32 v6, 16, v6
    v_add_f32 v6, v6, v56
    v_cvt_pk_bf16_f32 v6, v6, v6
    v_lshlrev_b32 v56, 16, v6
    v_lshlrev_b32 v6, 16, v123
    v_mul_f32 v6, v6, v86
    v_cvt_pk_bf16_f32 v6, v6, v6
    v_lshlrev_b32 v6, 16, v6
    v_add_f32 v6, v6, v66
    v_cvt_pk_bf16_f32 v6, v6, v6
    v_lshlrev_b32 v66, 16, v6
    v_and_b32 v6, 0xffff0000, v123
    v_mul_f32 v6, v6, v86
    v_cvt_pk_bf16_f32 v6, v6, v6
    v_lshlrev_b32 v6, 16, v6
    v_add_f32 v6, v6, v76
    v_cvt_pk_bf16_f32 v6, v6, v6
    v_lshlrev_b32 v76, 16, v6
    v_lshlrev_b32 v6, 16, v124
    v_mul_f32 v6, v6, v87
    v_cvt_pk_bf16_f32 v6, v6, v6
    v_lshlrev_b32 v6, 16, v6
    v_add_f32 v6, v6, v47
    v_cvt_pk_bf16_f32 v6, v6, v6
    v_lshlrev_b32 v47, 16, v6
    v_and_b32 v6, 0xffff0000, v124
    v_mul_f32 v6, v6, v87
    v_cvt_pk_bf16_f32 v6, v6, v6
    v_lshlrev_b32 v6, 16, v6
    v_add_f32 v6, v6, v57
    v_cvt_pk_bf16_f32 v6, v6, v6
    v_lshlrev_b32 v57, 16, v6
    v_lshlrev_b32 v6, 16, v125
    v_mul_f32 v6, v6, v87
    v_cvt_pk_bf16_f32 v6, v6, v6
    v_lshlrev_b32 v6, 16, v6
    v_add_f32 v6, v6, v67
    v_cvt_pk_bf16_f32 v6, v6, v6
    v_lshlrev_b32 v67, 16, v6
    v_and_b32 v6, 0xffff0000, v125
    v_mul_f32 v6, v6, v87
    v_cvt_pk_bf16_f32 v6, v6, v6
    v_lshlrev_b32 v6, 16, v6
    v_add_f32 v6, v6, v77
    v_cvt_pk_bf16_f32 v6, v6, v6
    v_lshlrev_b32 v77, 16, v6
    v_lshlrev_b32 v6, 16, v126
    v_mul_f32 v6, v6, v88
    v_cvt_pk_bf16_f32 v6, v6, v6
    v_lshlrev_b32 v6, 16, v6
    v_add_f32 v6, v6, v48
    v_cvt_pk_bf16_f32 v6, v6, v6
    v_lshlrev_b32 v48, 16, v6
    v_and_b32 v6, 0xffff0000, v126
    v_mul_f32 v6, v6, v88
    v_cvt_pk_bf16_f32 v6, v6, v6
    v_lshlrev_b32 v6, 16, v6
    v_add_f32 v6, v6, v58
    v_cvt_pk_bf16_f32 v6, v6, v6
    v_lshlrev_b32 v58, 16, v6
    v_lshlrev_b32 v6, 16, v127
    v_mul_f32 v6, v6, v88
    v_cvt_pk_bf16_f32 v6, v6, v6
    v_lshlrev_b32 v6, 16, v6
    v_add_f32 v6, v6, v68
    v_cvt_pk_bf16_f32 v6, v6, v6
    v_lshlrev_b32 v68, 16, v6
    v_and_b32 v6, 0xffff0000, v127
    v_mul_f32 v6, v6, v88
    v_cvt_pk_bf16_f32 v6, v6, v6
    v_lshlrev_b32 v6, 16, v6
    v_add_f32 v6, v6, v78
    v_cvt_pk_bf16_f32 v6, v6, v6
    v_lshlrev_b32 v78, 16, v6
    v_lshlrev_b32 v6, 16, v128
    v_mul_f32 v6, v6, v89
    v_cvt_pk_bf16_f32 v6, v6, v6
    v_lshlrev_b32 v6, 16, v6
    v_add_f32 v6, v6, v49
    v_cvt_pk_bf16_f32 v6, v6, v6
    v_lshlrev_b32 v49, 16, v6
    v_and_b32 v6, 0xffff0000, v128
    v_mul_f32 v6, v6, v89
    v_cvt_pk_bf16_f32 v6, v6, v6
    v_lshlrev_b32 v6, 16, v6
    v_add_f32 v6, v6, v59
    v_cvt_pk_bf16_f32 v6, v6, v6
    v_lshlrev_b32 v59, 16, v6
    v_lshlrev_b32 v6, 16, v129
    v_mul_f32 v6, v6, v89
    v_cvt_pk_bf16_f32 v6, v6, v6
    v_lshlrev_b32 v6, 16, v6
    v_add_f32 v6, v6, v69
    v_cvt_pk_bf16_f32 v6, v6, v6
    v_lshlrev_b32 v69, 16, v6
    v_and_b32 v6, 0xffff0000, v129
    v_mul_f32 v6, v6, v89
    v_cvt_pk_bf16_f32 v6, v6, v6
    v_lshlrev_b32 v6, 16, v6
    v_add_f32 v6, v6, v79
    v_cvt_pk_bf16_f32 v6, v6, v6
    v_lshlrev_b32 v79, 16, v6
    s_add_u32 s12, s6, 9437184
    s_addc_u32 s13, s7, 0
    s_add_u32 s14, s6, 12582912
    s_addc_u32 s15, s7, 0
    v_mov_b32 v3, v2
    v_cvt_pk_bf16_f32 v8, v40, v41
    v_cvt_pk_bf16_f32 v9, v42, v43
    v_cvt_pk_bf16_f32 v10, v44, v45
    v_cvt_pk_bf16_f32 v11, v46, v47
    v_cvt_pk_bf16_f32 v12, v48, v49
    global_store_dwordx4 v3, v[8:11], s[12:13]
    global_store_dword v3, v12, s[12:13] offset:16
    v_add_u32 v3, 1280, v3
    s_nop 1
    v_cvt_pk_bf16_f32 v8, v50, v51
    v_cvt_pk_bf16_f32 v9, v52, v53
    v_cvt_pk_bf16_f32 v10, v54, v55
    v_cvt_pk_bf16_f32 v11, v56, v57
    v_cvt_pk_bf16_f32 v12, v58, v59
    global_store_dwordx4 v3, v[8:11], s[12:13]
    global_store_dword v3, v12, s[12:13] offset:16
    v_add_u32 v3, 1280, v3
    s_nop 1
    v_cvt_pk_bf16_f32 v8, v60, v61
    v_cvt_pk_bf16_f32 v9, v62, v63
    v_cvt_pk_bf16_f32 v10, v64, v65
    v_cvt_pk_bf16_f32 v11, v66, v67
    v_cvt_pk_bf16_f32 v12, v68, v69
    global_store_dwordx4 v3, v[8:11], s[12:13]
    global_store_dword v3, v12, s[12:13] offset:16
    v_add_u32 v3, 1280, v3
    s_nop 1
    v_cvt_pk_bf16_f32 v8, v70, v71
    v_cvt_pk_bf16_f32 v9, v72, v73
    v_cvt_pk_bf16_f32 v10, v74, v75
    v_cvt_pk_bf16_f32 v11, v76, v77
    v_cvt_pk_bf16_f32 v12, v78, v79
    global_store_dwordx4 v3, v[8:11], s[12:13]
    global_store_dword v3, v12, s[12:13] offset:16
    v_add_u32 v3, 1280, v3
    s_nop 1
    v_add_f32 v28, v40, v41
    v_add_f32 v28, v28, v42
    v_add_f32 v28, v28, v43
    v_add_f32 v28, v28, v44
    v_add_f32 v28, v28, v45
    v_add_f32 v28, v28, v46
    v_add_f32 v28, v28, v47
    v_add_f32 v28, v28, v48
    v_add_f32 v28, v28, v49
    v_add_f32 v29, v50, v51
    v_add_f32 v29, v29, v52
    v_add_f32 v29, v29, v53
    v_add_f32 v29, v29, v54
    v_add_f32 v29, v29, v55
    v_add_f32 v29, v29, v56
    v_add_f32 v29, v29, v57
    v_add_f32 v29, v29, v58
    v_add_f32 v29, v29, v59
    v_add_f32 v30, v60, v61
    v_add_f32 v30, v30, v62
    v_add_f32 v30, v30, v63
    v_add_f32 v30, v30, v64
    v_add_f32 v30, v30, v65
    v_add_f32 v30, v30, v66
    v_add_f32 v30, v30, v67
    v_add_f32 v30, v30, v68
    v_add_f32 v30, v30, v69
    v_add_f32 v31, v70, v71
    v_add_f32 v31, v31, v72
    v_add_f32 v31, v31, v73
    v_add_f32 v31, v31, v74
    v_add_f32 v31, v31, v75
    v_add_f32 v31, v31, v76
    v_add_f32 v31, v31, v77
    v_add_f32 v31, v31, v78
    v_add_f32 v31, v31, v79
    v_xor_b32 v32, 4, v5
    ds_bpermute_b32 v33, v32, v28
    ds_bpermute_b32 v34, v32, v29
    ds_bpermute_b32 v35, v32, v30
    ds_bpermute_b32 v36, v32, v31
    s_waitcnt lgkmcnt(0)
    v_add_f32 v28, v28, v33
    v_add_f32 v29, v29, v34
    v_add_f32 v30, v30, v35
    v_add_f32 v31, v31, v36
    v_xor_b32 v32, 8, v5
    ds_bpermute_b32 v33, v32, v28
    ds_bpermute_b32 v34, v32, v29
    ds_bpermute_b32 v35, v32, v30
    ds_bpermute_b32 v36, v32, v31
    s_waitcnt lgkmcnt(0)
    v_add_f32 v28, v28, v33
    v_add_f32 v29, v29, v34
    v_add_f32 v30, v30, v35
    v_add_f32 v31, v31, v36
    v_xor_b32 v32, 16, v5
    ds_bpermute_b32 v33, v32, v28
    ds_bpermute_b32 v34, v32, v29
    ds_bpermute_b32 v35, v32, v30
    ds_bpermute_b32 v36, v32, v31
    s_waitcnt lgkmcnt(0)
    v_add_f32 v28, v28, v33
    v_add_f32 v29, v29, v34
    v_add_f32 v30, v30, v35
    v_add_f32 v31, v31, v36
    v_xor_b32 v32, 32, v5
    ds_bpermute_b32 v33, v32, v28
    ds_bpermute_b32 v34, v32, v29
    ds_bpermute_b32 v35, v32, v30
    ds_bpermute_b32 v36, v32, v31
    s_waitcnt lgkmcnt(0)
    v_add_f32 v28, v28, v33
    v_add_f32 v29, v29, v34
    v_add_f32 v30, v30, v35
    v_add_f32 v31, v31, v36
    v_xor_b32 v32, 64, v5
    ds_bpermute_b32 v33, v32, v28
    ds_bpermute_b32 v34, v32, v29
    ds_bpermute_b32 v35, v32, v30
    ds_bpermute_b32 v36, v32, v31
    s_waitcnt lgkmcnt(0)
    v_add_f32 v28, v28, v33
    v_add_f32 v29, v29, v34
    v_add_f32 v30, v30, v35
    v_add_f32 v31, v31, v36
    v_xor_b32 v32, 128, v5
    ds_bpermute_b32 v33, v32, v28
    ds_bpermute_b32 v34, v32, v29
    ds_bpermute_b32 v35, v32, v30
    ds_bpermute_b32 v36, v32, v31
    s_waitcnt lgkmcnt(0)
    v_add_f32 v28, v28, v33
    v_add_f32 v29, v29, v34
    v_add_f32 v30, v30, v35
    v_add_f32 v31, v31, v36
    v_mul_f32 v28, 0x3acccccd, v28
    v_sub_f32 v40, v40, v28
    v_sub_f32 v41, v41, v28
    v_sub_f32 v42, v42, v28
    v_sub_f32 v43, v43, v28
    v_sub_f32 v44, v44, v28
    v_sub_f32 v45, v45, v28
    v_sub_f32 v46, v46, v28
    v_sub_f32 v47, v47, v28
    v_sub_f32 v48, v48, v28
    v_sub_f32 v49, v49, v28
    v_mul_f32 v29, 0x3acccccd, v29
    v_sub_f32 v50, v50, v29
    v_sub_f32 v51, v51, v29
    v_sub_f32 v52, v52, v29
    v_sub_f32 v53, v53, v29
    v_sub_f32 v54, v54, v29
    v_sub_f32 v55, v55, v29
    v_sub_f32 v56, v56, v29
    v_sub_f32 v57, v57, v29
    v_sub_f32 v58, v58, v29
    v_sub_f32 v59, v59, v29
    v_mul_f32 v30, 0x3acccccd, v30
    v_sub_f32 v60, v60, v30
    v_sub_f32 v61, v61, v30
    v_sub_f32 v62, v62, v30
    v_sub_f32 v63, v63, v30
    v_sub_f32 v64, v64, v30
    v_sub_f32 v65, v65, v30
    v_sub_f32 v66, v66, v30
    v_sub_f32 v67, v67, v30
    v_sub_f32 v68, v68, v30
    v_sub_f32 v69, v69, v30
    v_mul_f32 v31, 0x3acccccd, v31
    v_sub_f32 v70, v70, v31
    v_sub_f32 v71, v71, v31
    v_sub_f32 v72, v72, v31
    v_sub_f32 v73, v73, v31
    v_sub_f32 v74, v74, v31
    v_sub_f32 v75, v75, v31
    v_sub_f32 v76, v76, v31
    v_sub_f32 v77, v77, v31
    v_sub_f32 v78, v78, v31
    v_sub_f32 v79, v79, v31
    v_mul_f32 v28, v40, v40
    v_fma_f32 v28, v41, v41, v28
    v_fma_f32 v28, v42, v42, v28
    v_fma_f32 v28, v43, v43, v28
    v_fma_f32 v28, v44, v44, v28
    v_fma_f32 v28, v45, v45, v28
    v_fma_f32 v28, v46, v46, v28
    v_fma_f32 v28, v47, v47, v28
    v_fma_f32 v28, v48, v48, v28
    v_fma_f32 v28, v49, v49, v28
    v_mul_f32 v29, v50, v50
    v_fma_f32 v29, v51, v51, v29
    v_fma_f32 v29, v52, v52, v29
    v_fma_f32 v29, v53, v53, v29
    v_fma_f32 v29, v54, v54, v29
    v_fma_f32 v29, v55, v55, v29
    v_fma_f32 v29, v56, v56, v29
    v_fma_f32 v29, v57, v57, v29
    v_fma_f32 v29, v58, v58, v29
    v_fma_f32 v29, v59, v59, v29
    v_mul_f32 v30, v60, v60
    v_fma_f32 v30, v61, v61, v30
    v_fma_f32 v30, v62, v62, v30
    v_fma_f32 v30, v63, v63, v30
    v_fma_f32 v30, v64, v64, v30
    v_fma_f32 v30, v65, v65, v30
    v_fma_f32 v30, v66, v66, v30
    v_fma_f32 v30, v67, v67, v30
    v_fma_f32 v30, v68, v68, v30
    v_fma_f32 v30, v69, v69, v30
    v_mul_f32 v31, v70, v70
    v_fma_f32 v31, v71, v71, v31
    v_fma_f32 v31, v72, v72, v31
    v_fma_f32 v31, v73, v73, v31
    v_fma_f32 v31, v74, v74, v31
    v_fma_f32 v31, v75, v75, v31
    v_fma_f32 v31, v76, v76, v31
    v_fma_f32 v31, v77, v77, v31
    v_fma_f32 v31, v78, v78, v31
    v_fma_f32 v31, v79, v79, v31
    v_xor_b32 v32, 4, v5
    ds_bpermute_b32 v33, v32, v28
    ds_bpermute_b32 v34, v32, v29
    ds_bpermute_b32 v35, v32, v30
    ds_bpermute_b32 v36, v32, v31
    s_waitcnt lgkmcnt(0)
    v_add_f32 v28, v28, v33
    v_add_f32 v29, v29, v34
    v_add_f32 v30, v30, v35
    v_add_f32 v31, v31, v36
    v_xor_b32 v32, 8, v5
    ds_bpermute_b32 v33, v32, v28
    ds_bpermute_b32 v34, v32, v29
    ds_bpermute_b32 v35, v32, v30
    ds_bpermute_b32 v36, v32, v31
    s_waitcnt lgkmcnt(0)
    v_add_f32 v28, v28, v33
    v_add_f32 v29, v29, v34
    v_add_f32 v30, v30, v35
    v_add_f32 v31, v31, v36
    v_xor_b32 v32, 16, v5
    ds_bpermute_b32 v33, v32, v28
    ds_bpermute_b32 v34, v32, v29
    ds_bpermute_b32 v35, v32, v30
    ds_bpermute_b32 v36, v32, v31
    s_waitcnt lgkmcnt(0)
    v_add_f32 v28, v28, v33
    v_add_f32 v29, v29, v34
    v_add_f32 v30, v30, v35
    v_add_f32 v31, v31, v36
    v_xor_b32 v32, 32, v5
    ds_bpermute_b32 v33, v32, v28
    ds_bpermute_b32 v34, v32, v29
    ds_bpermute_b32 v35, v32, v30
    ds_bpermute_b32 v36, v32, v31
    s_waitcnt lgkmcnt(0)
    v_add_f32 v28, v28, v33
    v_add_f32 v29, v29, v34
    v_add_f32 v30, v30, v35
    v_add_f32 v31, v31, v36
    v_xor_b32 v32, 64, v5
    ds_bpermute_b32 v33, v32, v28
    ds_bpermute_b32 v34, v32, v29
    ds_bpermute_b32 v35, v32, v30
    ds_bpermute_b32 v36, v32, v31
    s_waitcnt lgkmcnt(0)
    v_add_f32 v28, v28, v33
    v_add_f32 v29, v29, v34
    v_add_f32 v30, v30, v35
    v_add_f32 v31, v31, v36
    v_xor_b32 v32, 128, v5
    ds_bpermute_b32 v33, v32, v28
    ds_bpermute_b32 v34, v32, v29
    ds_bpermute_b32 v35, v32, v30
    ds_bpermute_b32 v36, v32, v31
    s_waitcnt lgkmcnt(0)
    v_add_f32 v28, v28, v33
    v_add_f32 v29, v29, v34
    v_add_f32 v30, v30, v35
    v_add_f32 v31, v31, v36
    v_mul_f32 v28, 0x3acccccd, v28
    v_add_f32 v28, 0x3727c5ac, v28
    v_rsq_f32 v28, v28
    s_nop 0
    v_mul_f32 v40, v40, v28
    v_mul_f32 v41, v41, v28
    v_mul_f32 v42, v42, v28
    v_mul_f32 v43, v43, v28
    v_mul_f32 v44, v44, v28
    v_mul_f32 v45, v45, v28
    v_mul_f32 v46, v46, v28
    v_mul_f32 v47, v47, v28
    v_mul_f32 v48, v48, v28
    v_mul_f32 v49, v49, v28
    v_mul_f32 v29, 0x3acccccd, v29
    v_add_f32 v29, 0x3727c5ac, v29
    v_rsq_f32 v29, v29
    s_nop 0
    v_mul_f32 v50, v50, v29
    v_mul_f32 v51, v51, v29
    v_mul_f32 v52, v52, v29
    v_mul_f32 v53, v53, v29
    v_mul_f32 v54, v54, v29
    v_mul_f32 v55, v55, v29
    v_mul_f32 v56, v56, v29
    v_mul_f32 v57, v57, v29
    v_mul_f32 v58, v58, v29
    v_mul_f32 v59, v59, v29
    v_mul_f32 v30, 0x3acccccd, v30
    v_add_f32 v30, 0x3727c5ac, v30
    v_rsq_f32 v30, v30
    s_nop 0
    v_mul_f32 v60, v60, v30
    v_mul_f32 v61, v61, v30
    v_mul_f32 v62, v62, v30
    v_mul_f32 v63, v63, v30
    v_mul_f32 v64, v64, v30
    v_mul_f32 v65, v65, v30
    v_mul_f32 v66, v66, v30
    v_mul_f32 v67, v67, v30
    v_mul_f32 v68, v68, v30
    v_mul_f32 v69, v69, v30
    v_mul_f32 v31, 0x3acccccd, v31
    v_add_f32 v31, 0x3727c5ac, v31
    v_rsq_f32 v31, v31
    s_nop 0
    v_mul_f32 v70, v70, v31
    v_mul_f32 v71, v71, v31
    v_mul_f32 v72, v72, v31
    v_mul_f32 v73, v73, v31
    v_mul_f32 v74, v74, v31
    v_mul_f32 v75, v75, v31
    v_mul_f32 v76, v76, v31
    v_mul_f32 v77, v77, v31
    v_mul_f32 v78, v78, v31
    v_mul_f32 v79, v79, v31
    v_add_f32 v100, 1.0, v100
    v_add_f32 v101, 1.0, v101
    v_cvt_pk_bf16_f32 v6, v100, v101
    v_lshlrev_b32 v100, 16, v6
    v_and_b32 v101, 0xffff0000, v6
    v_add_f32 v102, 1.0, v102
    v_add_f32 v103, 1.0, v103
    v_cvt_pk_bf16_f32 v6, v102, v103
    v_lshlrev_b32 v102, 16, v6
    v_and_b32 v103, 0xffff0000, v6
    v_add_f32 v104, 1.0, v104
    v_add_f32 v105, 1.0, v105
    v_cvt_pk_bf16_f32 v6, v104, v105
    v_lshlrev_b32 v104, 16, v6
    v_and_b32 v105, 0xffff0000, v6
    v_add_f32 v106, 1.0, v106
    v_add_f32 v107, 1.0, v107
    v_cvt_pk_bf16_f32 v6, v106, v107
    v_lshlrev_b32 v106, 16, v6
    v_and_b32 v107, 0xffff0000, v6
    v_add_f32 v108, 1.0, v108
    v_add_f32 v109, 1.0, v109
    v_cvt_pk_bf16_f32 v6, v108, v109
    v_lshlrev_b32 v108, 16, v6
    v_and_b32 v109, 0xffff0000, v6
    v_fma_f32 v40, v40, v100, v90
    v_fma_f32 v41, v41, v101, v91
    v_fma_f32 v42, v42, v102, v92
    v_fma_f32 v43, v43, v103, v93
    v_fma_f32 v44, v44, v104, v94
    v_fma_f32 v45, v45, v105, v95
    v_fma_f32 v46, v46, v106, v96
    v_fma_f32 v47, v47, v107, v97
    v_fma_f32 v48, v48, v108, v98
    v_fma_f32 v49, v49, v109, v99
    v_fma_f32 v50, v50, v100, v90
    v_fma_f32 v51, v51, v101, v91
    v_fma_f32 v52, v52, v102, v92
    v_fma_f32 v53, v53, v103, v93
    v_fma_f32 v54, v54, v104, v94
    v_fma_f32 v55, v55, v105, v95
    v_fma_f32 v56, v56, v106, v96
    v_fma_f32 v57, v57, v107, v97
    v_fma_f32 v58, v58, v108, v98
    v_fma_f32 v59, v59, v109, v99
    v_fma_f32 v60, v60, v100, v90
    v_fma_f32 v61, v61, v101, v91
    v_fma_f32 v62, v62, v102, v92
    v_fma_f32 v63, v63, v103, v93
    v_fma_f32 v64, v64, v104, v94
    v_fma_f32 v65, v65, v105, v95
    v_fma_f32 v66, v66, v106, v96
    v_fma_f32 v67, v67, v107, v97
    v_fma_f32 v68, v68, v108, v98
    v_fma_f32 v69, v69, v109, v99
    v_fma_f32 v70, v70, v100, v90
    v_fma_f32 v71, v71, v101, v91
    v_fma_f32 v72, v72, v102, v92
    v_fma_f32 v73, v73, v103, v93
    v_fma_f32 v74, v74, v104, v94
    v_fma_f32 v75, v75, v105, v95
    v_fma_f32 v76, v76, v106, v96
    v_fma_f32 v77, v77, v107, v97
    v_fma_f32 v78, v78, v108, v98
    v_fma_f32 v79, v79, v109, v99
    v_mov_b32 v3, v2
    v_cvt_pk_bf16_f32 v8, v40, v41
    v_cvt_pk_bf16_f32 v9, v42, v43
    v_cvt_pk_bf16_f32 v10, v44, v45
    v_cvt_pk_bf16_f32 v11, v46, v47
    v_cvt_pk_bf16_f32 v12, v48, v49
    global_store_dwordx4 v3, v[8:11], s[14:15]
    global_store_dword v3, v12, s[14:15] offset:16
    v_add_u32 v3, 1280, v3
    s_nop 1
    v_cvt_pk_bf16_f32 v8, v50, v51
    v_cvt_pk_bf16_f32 v9, v52, v53
    v_cvt_pk_bf16_f32 v10, v54, v55
    v_cvt_pk_bf16_f32 v11, v56, v57
    v_cvt_pk_bf16_f32 v12, v58, v59
    global_store_dwordx4 v3, v[8:11], s[14:15]
    global_store_dword v3, v12, s[14:15] offset:16
    v_add_u32 v3, 1280, v3
    s_nop 1
    v_cvt_pk_bf16_f32 v8, v60, v61
    v_cvt_pk_bf16_f32 v9, v62, v63
    v_cvt_pk_bf16_f32 v10, v64, v65
    v_cvt_pk_bf16_f32 v11, v66, v67
    v_cvt_pk_bf16_f32 v12, v68, v69
    global_store_dwordx4 v3, v[8:11], s[14:15]
    global_store_dword v3, v12, s[14:15] offset:16
    v_add_u32 v3, 1280, v3
    s_nop 1
    v_cvt_pk_bf16_f32 v8, v70, v71
    v_cvt_pk_bf16_f32 v9, v72, v73
    v_cvt_pk_bf16_f32 v10, v74, v75
    v_cvt_pk_bf16_f32 v11, v76, v77
    v_cvt_pk_bf16_f32 v12, v78, v79
    global_store_dwordx4 v3, v[8:11], s[14:15]
    global_store_dword v3, v12, s[14:15] offset:16
    v_add_u32 v3, 1280, v3
    s_nop 1
.ln2_done:
    s_endpgm
.globl gemm1_kernel
.p2align 8
.type gemm1_kernel,@function
gemm1_kernel:
    s_cmp_ge_u32 s2, 216
    s_cbranch_scc1 .gemm1_kernel_done
    s_load_dwordx2 s[6:7], s[0:1], 136
    s_load_dwordx4 s[8:11], s[0:1], 80
    s_load_dwordx2 s[12:13], s[0:1], 96
    s_load_dwordx2 s[14:15], s[0:1], 120
    s_and_b32 s16, s2, 7
    s_mul_i32 s16, s16, 27
    s_lshr_b32 s17, s2, 3
    s_add_u32 s16, s16, s17
    s_lshr_b32 s18, s16, 3
    s_and_b32 s17, s16, 7
    v_lshrrev_b32 v1, 6, v0
    s_nop 0
    v_readfirstlane_b32 s23, v1
    s_waitcnt lgkmcnt(0)
    s_add_u32 s4, s6, 12582912
    s_addc_u32 s5, s7, 0

    v_and_b32 v13, 63, v0
    s_lshr_b32 s24, s23, 1
    s_and_b32 s25, s23, 1
    v_lshrrev_b32 v1, 3, v13
    v_and_b32 v2, 7, v13
    v_lshrrev_b32 v6, 4, v13
    v_xor_b32 v2, v2, v6
    v_xor_b32 v6, 4, v2
    s_mul_i32 s19, s17, 256
    s_lshl_b32 s26, s23, 5
    s_add_u32 s19, s19, s26
    v_add_u32 v3, s19, v1
    v_mul_lo_u32 v3, v3, 20
    v_lshlrev_b32 v3, 6, v3
    v_lshlrev_b32 v4, 4, v2
    v_lshlrev_b32 v6, 4, v6
    v_add_u32 v6, v3, v6
    v_add_u32 v3, v3, v4
    v_mov_b32 v5, s5
    v_add_co_u32 v4, vcc, s4, v3
    v_addc_co_u32 v5, vcc, 0, v5, vcc
    v_mov_b32 v19, s5
    v_add_co_u32 v18, vcc, s4, v6
    v_addc_co_u32 v19, vcc, 0, v19, vcc

    v_lshrrev_b32 v1, 4, v13
    v_and_b32 v2, 15, v13
    v_lshlrev_b32 v6, 2, v1
    v_xor_b32 v2, v2, v6
    s_lshl_b32 s26, s23, 3
    v_add_u32 v1, s26, v1
    v_mul_u32_u24 v6, 3456, v1
    v_and_b32 v7, 7, v2
    v_lshlrev_b32 v7, 4, v7
    v_add_u32 v6, v6, v7
    s_lshl_b32 s20, s18, 7
    v_add_u32 v6, s20, v6
    v_cmp_gt_u32 vcc, 8, v2
    v_mov_b32 v8, s10
    v_mov_b32 v9, s8
    s_nop 0
    v_cndmask_b32 v8, v8, v9, vcc
    v_mov_b32 v9, s11
    v_mov_b32 v10, s9
    v_cndmask_b32 v9, v9, v10, vcc
    v_add_co_u32 v8, vcc, v8, v6
    v_addc_co_u32 v9, vcc, 0, v9, vcc

    v_mov_b32 v96, 0
    v_mov_b32 v97, 0
    v_mov_b32 v98, 0
    v_mov_b32 v99, 0
    v_mov_b32 v100, 0
    v_mov_b32 v101, 0
    v_mov_b32 v102, 0
    v_mov_b32 v103, 0
    v_mov_b32 v104, 0
    v_mov_b32 v105, 0
    v_mov_b32 v106, 0
    v_mov_b32 v107, 0
    v_mov_b32 v108, 0
    v_mov_b32 v109, 0
    v_mov_b32 v110, 0
    v_mov_b32 v111, 0
    v_mov_b32 v112, 0
    v_mov_b32 v113, 0
    v_mov_b32 v114, 0
    v_mov_b32 v115, 0
    v_mov_b32 v116, 0
    v_mov_b32 v117, 0
    v_mov_b32 v118, 0
    v_mov_b32 v119, 0
    v_mov_b32 v120, 0
    v_mov_b32 v121, 0
    v_mov_b32 v122, 0
    v_mov_b32 v123, 0
    v_mov_b32 v124, 0
    v_mov_b32 v125, 0
    v_mov_b32 v126, 0
    v_mov_b32 v127, 0
    v_mov_b32 v128, 0
    v_mov_b32 v129, 0
    v_mov_b32 v130, 0
    v_mov_b32 v131, 0
    v_mov_b32 v132, 0
    v_mov_b32 v133, 0
    v_mov_b32 v134, 0
    v_mov_b32 v135, 0
    v_mov_b32 v136, 0
    v_mov_b32 v137, 0
    v_mov_b32 v138, 0
    v_mov_b32 v139, 0
    v_mov_b32 v140, 0
    v_mov_b32 v141, 0
    v_mov_b32 v142, 0
    v_mov_b32 v143, 0
    v_mov_b32 v144, 0
    v_mov_b32 v145, 0
    v_mov_b32 v146, 0
    v_mov_b32 v147, 0
    v_mov_b32 v148, 0
    v_mov_b32 v149, 0
    v_mov_b32 v150, 0
    v_mov_b32 v151, 0
    v_mov_b32 v152, 0
    v_mov_b32 v153, 0
    v_mov_b32 v154, 0
    v_mov_b32 v155, 0
    v_mov_b32 v156, 0
    v_mov_b32 v157, 0
    v_mov_b32 v158, 0
    v_mov_b32 v159, 0
    v_and_b32 v1, 31, v0
    v_bfe_u32 v2, v0, 5, 1
    s_lshl_b32 s26, s24, 13
    v_lshlrev_b32 v6, 7, v1
    v_add_u32 v6, s26, v6
    v_bfe_u32 v7, v1, 1, 3

    v_add_u32 v12, 0, v2
    v_xor_b32 v12, v12, v7
    v_lshlrev_b32 v12, 4, v12
    v_add_u32 v40, v6, v12
    v_add_u32 v12, 2, v2
    v_xor_b32 v12, v12, v7
    v_lshlrev_b32 v12, 4, v12
    v_add_u32 v41, v6, v12
    v_add_u32 v12, 4, v2
    v_xor_b32 v12, v12, v7
    v_lshlrev_b32 v12, 4, v12
    v_add_u32 v42, v6, v12
    v_add_u32 v12, 6, v2
    v_xor_b32 v12, v12, v7
    v_lshlrev_b32 v12, 4, v12
    v_add_u32 v43, v6, v12
    v_bfe_u32 v6, v0, 2, 2
    v_and_b32 v7, 3, v0
    v_bfe_u32 v12, v0, 4, 1
    v_lshlrev_b32 v14, 3, v2
    v_add_u32 v14, v14, v6
    v_mul_u32_u24 v14, 256, v14
    v_add_u32 v14, 32768, v14
    v_and_b32 v15, 1, v7
    v_lshlrev_b32 v15, 3, v15
    v_add_u32 v14, v14, v15
    v_lshrrev_b32 v7, 1, v7
    v_lshlrev_b32 v12, 1, v12
    v_add_u32 v7, v7, v12
    s_lshl_b32 s26, s25, 2
    v_add_u32 v7, s26, v7

    v_lshlrev_b32 v6, 2, v6
    v_add_u32 v12, 0, v7
    v_xor_b32 v12, v12, v6
    v_lshlrev_b32 v12, 4, v12
    v_add_u32 v44, v14, v12
    v_add_u32 v12, 8, v7
    v_xor_b32 v12, v12, v6
    v_lshlrev_b32 v12, 4, v12
    v_add_u32 v45, v14, v12
    s_lshl_b32 s30, s23, 12
    s_mul_i32 s31, s23, 2048
    s_add_u32 s31, s31, 32768
    s_mov_b32 s28, 0
    s_add_u32 s29, s28, s30
    s_add_u32 m0, s29, 0
    v_add_co_u32 v14, vcc, 0, v4
    v_addc_co_u32 v15, vcc, 0, v5, vcc
    global_load_lds_dwordx4 v[14:15], off
    s_add_u32 s29, s28, s30
    s_add_u32 m0, s29, 1024
    v_add_co_u32 v14, vcc, 10240, v18
    v_addc_co_u32 v15, vcc, 0, v19, vcc
    global_load_lds_dwordx4 v[14:15], off
    s_add_u32 s29, s28, s30
    s_add_u32 m0, s29, 2048
    v_add_co_u32 v14, vcc, 20480, v4
    v_addc_co_u32 v15, vcc, 0, v5, vcc
    global_load_lds_dwordx4 v[14:15], off
    s_add_u32 s29, s28, s30
    s_add_u32 m0, s29, 3072
    v_add_co_u32 v14, vcc, 30720, v18
    v_addc_co_u32 v15, vcc, 0, v19, vcc
    global_load_lds_dwordx4 v[14:15], off
    s_add_u32 s29, s28, s31
    s_add_u32 m0, s29, 0
    v_add_co_u32 v14, vcc, 0, v8
    v_addc_co_u32 v15, vcc, 0, v9, vcc
    global_load_lds_dwordx4 v[14:15], off
    s_add_u32 s29, s28, s31
    s_add_u32 m0, s29, 1024
    v_add_co_u32 v14, vcc, 13824, v8
    v_addc_co_u32 v15, vcc, 0, v9, vcc
    global_load_lds_dwordx4 v[14:15], off
    v_add_co_u32 v4, vcc, 128, v4
    v_addc_co_u32 v5, vcc, 0, v5, vcc
    v_add_co_u32 v18, vcc, 128, v18
    v_addc_co_u32 v19, vcc, 0, v19, vcc
    v_add_co_u32 v8, vcc, 221184, v8
    v_addc_co_u32 v9, vcc, 0, v9, vcc
    s_add_u32 s28, s28, 49152
    s_cmp_eq_u32 s28, 147456
    s_cselect_b32 s28, 0, s28
    s_add_u32 s29, s28, s30
    s_add_u32 m0, s29, 0
    v_add_co_u32 v14, vcc, 0, v4
    v_addc_co_u32 v15, vcc, 0, v5, vcc
    global_load_lds_dwordx4 v[14:15], off
    s_add_u32 s29, s28, s30
    s_add_u32 m0, s29, 1024
    v_add_co_u32 v14, vcc, 10240, v18
    v_addc_co_u32 v15, vcc, 0, v19, vcc
    global_load_lds_dwordx4 v[14:15], off
    s_add_u32 s29, s28, s30
    s_add_u32 m0, s29, 2048
    v_add_co_u32 v14, vcc, 20480, v4
    v_addc_co_u32 v15, vcc, 0, v5, vcc
    global_load_lds_dwordx4 v[14:15], off
    s_add_u32 s29, s28, s30
    s_add_u32 m0, s29, 3072
    v_add_co_u32 v14, vcc, 30720, v18
    v_addc_co_u32 v15, vcc, 0, v19, vcc
    global_load_lds_dwordx4 v[14:15], off
    s_add_u32 s29, s28, s31
    s_add_u32 m0, s29, 0
    v_add_co_u32 v14, vcc, 0, v8
    v_addc_co_u32 v15, vcc, 0, v9, vcc
    global_load_lds_dwordx4 v[14:15], off
    s_add_u32 s29, s28, s31
    s_add_u32 m0, s29, 1024
    v_add_co_u32 v14, vcc, 13824, v8
    v_addc_co_u32 v15, vcc, 0, v9, vcc
    global_load_lds_dwordx4 v[14:15], off
    v_add_co_u32 v4, vcc, 128, v4
    v_addc_co_u32 v5, vcc, 0, v5, vcc
    v_add_co_u32 v18, vcc, 128, v18
    v_addc_co_u32 v19, vcc, 0, v19, vcc
    v_add_co_u32 v8, vcc, 221184, v8
    v_addc_co_u32 v9, vcc, 0, v9, vcc
    s_add_u32 s28, s28, 49152
    s_cmp_eq_u32 s28, 147456
    s_cselect_b32 s28, 0, s28
    s_mov_b32 s27, 0
    s_mov_b32 s21, 0
.gemm1_kernel_loop:
    s_cmp_ge_u32 s27, 8
    s_cbranch_scc1 .gemm1_kernel_tail
    s_waitcnt vmcnt(6)
    s_barrier
    s_add_u32 s29, s28, s30
    s_add_u32 m0, s29, 0
    v_add_co_u32 v14, vcc, 0, v4
    v_addc_co_u32 v15, vcc, 0, v5, vcc
    global_load_lds_dwordx4 v[14:15], off
    s_add_u32 s29, s28, s30
    s_add_u32 m0, s29, 1024
    v_add_co_u32 v14, vcc, 10240, v18
    v_addc_co_u32 v15, vcc, 0, v19, vcc
    global_load_lds_dwordx4 v[14:15], off
    s_add_u32 s29, s28, s30
    s_add_u32 m0, s29, 2048
    v_add_co_u32 v14, vcc, 20480, v4
    v_addc_co_u32 v15, vcc, 0, v5, vcc
    global_load_lds_dwordx4 v[14:15], off
    s_add_u32 s29, s28, s30
    s_add_u32 m0, s29, 3072
    v_add_co_u32 v14, vcc, 30720, v18
    v_addc_co_u32 v15, vcc, 0, v19, vcc
    global_load_lds_dwordx4 v[14:15], off
    s_add_u32 s29, s28, s31
    s_add_u32 m0, s29, 0
    v_add_co_u32 v14, vcc, 0, v8
    v_addc_co_u32 v15, vcc, 0, v9, vcc
    global_load_lds_dwordx4 v[14:15], off
    s_add_u32 s29, s28, s31
    s_add_u32 m0, s29, 1024
    v_add_co_u32 v14, vcc, 13824, v8
    v_addc_co_u32 v15, vcc, 0, v9, vcc
    global_load_lds_dwordx4 v[14:15], off
    v_add_co_u32 v4, vcc, 128, v4
    v_addc_co_u32 v5, vcc, 0, v5, vcc
    v_add_co_u32 v18, vcc, 128, v18
    v_addc_co_u32 v19, vcc, 0, v19, vcc
    v_add_co_u32 v8, vcc, 221184, v8
    v_addc_co_u32 v9, vcc, 0, v9, vcc
    s_add_u32 s28, s28, 49152
    s_cmp_eq_u32 s28, 147456
    s_cselect_b32 s28, 0, s28
    s_branch .gemm1_kernel_cmp
.gemm1_kernel_tail:
    s_waitcnt vmcnt(0)
    s_barrier
.gemm1_kernel_cmp:
    ds_read_b128 v[48:51], v40 offset:0
    ds_read_b128 v[52:55], v40 offset:4096
    ds_read_b64_tr_b16 v[56:57], v44 offset:0
    ds_read_b64_tr_b16 v[58:59], v44 offset:1024
    ds_read_b64_tr_b16 v[60:61], v45 offset:0
    ds_read_b64_tr_b16 v[62:63], v45 offset:1024
    ds_read_b128 v[64:67], v41 offset:0
    ds_read_b128 v[68:71], v41 offset:4096
    ds_read_b64_tr_b16 v[72:73], v44 offset:4096
    ds_read_b64_tr_b16 v[74:75], v44 offset:5120
    ds_read_b64_tr_b16 v[76:77], v45 offset:4096
    ds_read_b64_tr_b16 v[78:79], v45 offset:5120
    s_waitcnt lgkmcnt(6)
    v_mfma_f32_32x32x16_bf16 v[96:111], v[48:51], v[56:59], v[96:111]
    v_mfma_f32_32x32x16_bf16 v[112:127], v[48:51], v[60:63], v[112:127]
    v_mfma_f32_32x32x16_bf16 v[128:143], v[52:55], v[56:59], v[128:143]
    v_mfma_f32_32x32x16_bf16 v[144:159], v[52:55], v[60:63], v[144:159]
    ds_read_b128 v[48:51], v42 offset:0
    ds_read_b128 v[52:55], v42 offset:4096
    ds_read_b64_tr_b16 v[56:57], v44 offset:8192
    ds_read_b64_tr_b16 v[58:59], v44 offset:9216
    ds_read_b64_tr_b16 v[60:61], v45 offset:8192
    ds_read_b64_tr_b16 v[62:63], v45 offset:9216
    s_waitcnt lgkmcnt(6)
    v_mfma_f32_32x32x16_bf16 v[96:111], v[64:67], v[72:75], v[96:111]
    v_mfma_f32_32x32x16_bf16 v[112:127], v[64:67], v[76:79], v[112:127]
    v_mfma_f32_32x32x16_bf16 v[128:143], v[68:71], v[72:75], v[128:143]
    v_mfma_f32_32x32x16_bf16 v[144:159], v[68:71], v[76:79], v[144:159]
    ds_read_b128 v[64:67], v43 offset:0
    ds_read_b128 v[68:71], v43 offset:4096
    ds_read_b64_tr_b16 v[72:73], v44 offset:12288
    ds_read_b64_tr_b16 v[74:75], v44 offset:13312
    ds_read_b64_tr_b16 v[76:77], v45 offset:12288
    ds_read_b64_tr_b16 v[78:79], v45 offset:13312
    s_waitcnt lgkmcnt(6)
    v_mfma_f32_32x32x16_bf16 v[96:111], v[48:51], v[56:59], v[96:111]
    v_mfma_f32_32x32x16_bf16 v[112:127], v[48:51], v[60:63], v[112:127]
    v_mfma_f32_32x32x16_bf16 v[128:143], v[52:55], v[56:59], v[128:143]
    v_mfma_f32_32x32x16_bf16 v[144:159], v[52:55], v[60:63], v[144:159]
    s_waitcnt lgkmcnt(0)
    v_mfma_f32_32x32x16_bf16 v[96:111], v[64:67], v[72:75], v[96:111]
    v_mfma_f32_32x32x16_bf16 v[112:127], v[64:67], v[76:79], v[112:127]
    v_mfma_f32_32x32x16_bf16 v[128:143], v[68:71], v[72:75], v[128:143]
    v_mfma_f32_32x32x16_bf16 v[144:159], v[68:71], v[76:79], v[144:159]
    s_add_u32 s21, s21, 49152
    s_mov_b32 s29, 49152
    s_cmp_eq_u32 s21, 147456
    s_cselect_b32 s29, 4294868992, s29
    s_cselect_b32 s21, 0, s21

    v_add_u32 v40, s29, v40
    v_add_u32 v41, s29, v41
    v_add_u32 v42, s29, v42
    v_add_u32 v43, s29, v43
    v_add_u32 v44, s29, v44
    v_add_u32 v45, s29, v45
    s_add_u32 s27, s27, 1
    s_cmp_lt_u32 s27, 10
    s_cbranch_scc1 .gemm1_kernel_loop
    s_barrier
    s_nop 15
    s_nop 3
    s_mul_i32 s26, s24, 9216
    s_lshl_b32 s28, s25, 6
    s_add_u32 s26, s26, s28
    v_mul_u32_u24 v4, 576, v2
    v_lshlrev_b32 v5, 1, v1
    v_add_u32 v4, v4, v5
    v_add_u32 v4, s26, v4

    v_mul_f32 v12, 0xbfb8aa3b, v96
    v_exp_f32 v12, v12
    v_mul_f32 v8, v96, v112
    v_add_f32 v12, 1.0, v12
    v_rcp_f32 v12, v12
    s_nop 0
    v_mul_f32 v8, v8, v12
    v_cvt_pk_bf16_f32 v8, v8, v8
    ds_write_b16 v4, v8 offset:0

    v_mul_f32 v12, 0xbfb8aa3b, v97
    v_exp_f32 v12, v12
    v_mul_f32 v8, v97, v113
    v_add_f32 v12, 1.0, v12
    v_rcp_f32 v12, v12
    s_nop 0
    v_mul_f32 v8, v8, v12
    v_cvt_pk_bf16_f32 v8, v8, v8
    ds_write_b16 v4, v8 offset:144

    v_mul_f32 v12, 0xbfb8aa3b, v98
    v_exp_f32 v12, v12
    v_mul_f32 v8, v98, v114
    v_add_f32 v12, 1.0, v12
    v_rcp_f32 v12, v12
    s_nop 0
    v_mul_f32 v8, v8, v12
    v_cvt_pk_bf16_f32 v8, v8, v8
    ds_write_b16 v4, v8 offset:288

    v_mul_f32 v12, 0xbfb8aa3b, v99
    v_exp_f32 v12, v12
    v_mul_f32 v8, v99, v115
    v_add_f32 v12, 1.0, v12
    v_rcp_f32 v12, v12
    s_nop 0
    v_mul_f32 v8, v8, v12
    v_cvt_pk_bf16_f32 v8, v8, v8
    ds_write_b16 v4, v8 offset:432

    v_mul_f32 v12, 0xbfb8aa3b, v100
    v_exp_f32 v12, v12
    v_mul_f32 v8, v100, v116
    v_add_f32 v12, 1.0, v12
    v_rcp_f32 v12, v12
    s_nop 0
    v_mul_f32 v8, v8, v12
    v_cvt_pk_bf16_f32 v8, v8, v8
    ds_write_b16 v4, v8 offset:1152

    v_mul_f32 v12, 0xbfb8aa3b, v101
    v_exp_f32 v12, v12
    v_mul_f32 v8, v101, v117
    v_add_f32 v12, 1.0, v12
    v_rcp_f32 v12, v12
    s_nop 0
    v_mul_f32 v8, v8, v12
    v_cvt_pk_bf16_f32 v8, v8, v8
    ds_write_b16 v4, v8 offset:1296

    v_mul_f32 v12, 0xbfb8aa3b, v102
    v_exp_f32 v12, v12
    v_mul_f32 v8, v102, v118
    v_add_f32 v12, 1.0, v12
    v_rcp_f32 v12, v12
    s_nop 0
    v_mul_f32 v8, v8, v12
    v_cvt_pk_bf16_f32 v8, v8, v8
    ds_write_b16 v4, v8 offset:1440

    v_mul_f32 v12, 0xbfb8aa3b, v103
    v_exp_f32 v12, v12
    v_mul_f32 v8, v103, v119
    v_add_f32 v12, 1.0, v12
    v_rcp_f32 v12, v12
    s_nop 0
    v_mul_f32 v8, v8, v12
    v_cvt_pk_bf16_f32 v8, v8, v8
    ds_write_b16 v4, v8 offset:1584

    v_mul_f32 v12, 0xbfb8aa3b, v104
    v_exp_f32 v12, v12
    v_mul_f32 v8, v104, v120
    v_add_f32 v12, 1.0, v12
    v_rcp_f32 v12, v12
    s_nop 0
    v_mul_f32 v8, v8, v12
    v_cvt_pk_bf16_f32 v8, v8, v8
    ds_write_b16 v4, v8 offset:2304

    v_mul_f32 v12, 0xbfb8aa3b, v105
    v_exp_f32 v12, v12
    v_mul_f32 v8, v105, v121
    v_add_f32 v12, 1.0, v12
    v_rcp_f32 v12, v12
    s_nop 0
    v_mul_f32 v8, v8, v12
    v_cvt_pk_bf16_f32 v8, v8, v8
    ds_write_b16 v4, v8 offset:2448

    v_mul_f32 v12, 0xbfb8aa3b, v106
    v_exp_f32 v12, v12
    v_mul_f32 v8, v106, v122
    v_add_f32 v12, 1.0, v12
    v_rcp_f32 v12, v12
    s_nop 0
    v_mul_f32 v8, v8, v12
    v_cvt_pk_bf16_f32 v8, v8, v8
    ds_write_b16 v4, v8 offset:2592

    v_mul_f32 v12, 0xbfb8aa3b, v107
    v_exp_f32 v12, v12
    v_mul_f32 v8, v107, v123
    v_add_f32 v12, 1.0, v12
    v_rcp_f32 v12, v12
    s_nop 0
    v_mul_f32 v8, v8, v12
    v_cvt_pk_bf16_f32 v8, v8, v8
    ds_write_b16 v4, v8 offset:2736

    v_mul_f32 v12, 0xbfb8aa3b, v108
    v_exp_f32 v12, v12
    v_mul_f32 v8, v108, v124
    v_add_f32 v12, 1.0, v12
    v_rcp_f32 v12, v12
    s_nop 0
    v_mul_f32 v8, v8, v12
    v_cvt_pk_bf16_f32 v8, v8, v8
    ds_write_b16 v4, v8 offset:3456

    v_mul_f32 v12, 0xbfb8aa3b, v109
    v_exp_f32 v12, v12
    v_mul_f32 v8, v109, v125
    v_add_f32 v12, 1.0, v12
    v_rcp_f32 v12, v12
    s_nop 0
    v_mul_f32 v8, v8, v12
    v_cvt_pk_bf16_f32 v8, v8, v8
    ds_write_b16 v4, v8 offset:3600

    v_mul_f32 v12, 0xbfb8aa3b, v110
    v_exp_f32 v12, v12
    v_mul_f32 v8, v110, v126
    v_add_f32 v12, 1.0, v12
    v_rcp_f32 v12, v12
    s_nop 0
    v_mul_f32 v8, v8, v12
    v_cvt_pk_bf16_f32 v8, v8, v8
    ds_write_b16 v4, v8 offset:3744

    v_mul_f32 v12, 0xbfb8aa3b, v111
    v_exp_f32 v12, v12
    v_mul_f32 v8, v111, v127
    v_add_f32 v12, 1.0, v12
    v_rcp_f32 v12, v12
    s_nop 0
    v_mul_f32 v8, v8, v12
    v_cvt_pk_bf16_f32 v8, v8, v8
    ds_write_b16 v4, v8 offset:3888

    v_mul_f32 v12, 0xbfb8aa3b, v128
    v_exp_f32 v12, v12
    v_mul_f32 v8, v128, v144
    v_add_f32 v12, 1.0, v12
    v_rcp_f32 v12, v12
    s_nop 0
    v_mul_f32 v8, v8, v12
    v_cvt_pk_bf16_f32 v8, v8, v8
    ds_write_b16 v4, v8 offset:4608

    v_mul_f32 v12, 0xbfb8aa3b, v129
    v_exp_f32 v12, v12
    v_mul_f32 v8, v129, v145
    v_add_f32 v12, 1.0, v12
    v_rcp_f32 v12, v12
    s_nop 0
    v_mul_f32 v8, v8, v12
    v_cvt_pk_bf16_f32 v8, v8, v8
    ds_write_b16 v4, v8 offset:4752

    v_mul_f32 v12, 0xbfb8aa3b, v130
    v_exp_f32 v12, v12
    v_mul_f32 v8, v130, v146
    v_add_f32 v12, 1.0, v12
    v_rcp_f32 v12, v12
    s_nop 0
    v_mul_f32 v8, v8, v12
    v_cvt_pk_bf16_f32 v8, v8, v8
    ds_write_b16 v4, v8 offset:4896

    v_mul_f32 v12, 0xbfb8aa3b, v131
    v_exp_f32 v12, v12
    v_mul_f32 v8, v131, v147
    v_add_f32 v12, 1.0, v12
    v_rcp_f32 v12, v12
    s_nop 0
    v_mul_f32 v8, v8, v12
    v_cvt_pk_bf16_f32 v8, v8, v8
    ds_write_b16 v4, v8 offset:5040

    v_mul_f32 v12, 0xbfb8aa3b, v132
    v_exp_f32 v12, v12
    v_mul_f32 v8, v132, v148
    v_add_f32 v12, 1.0, v12
    v_rcp_f32 v12, v12
    s_nop 0
    v_mul_f32 v8, v8, v12
    v_cvt_pk_bf16_f32 v8, v8, v8
    ds_write_b16 v4, v8 offset:5760

    v_mul_f32 v12, 0xbfb8aa3b, v133
    v_exp_f32 v12, v12
    v_mul_f32 v8, v133, v149
    v_add_f32 v12, 1.0, v12
    v_rcp_f32 v12, v12
    s_nop 0
    v_mul_f32 v8, v8, v12
    v_cvt_pk_bf16_f32 v8, v8, v8
    ds_write_b16 v4, v8 offset:5904

    v_mul_f32 v12, 0xbfb8aa3b, v134
    v_exp_f32 v12, v12
    v_mul_f32 v8, v134, v150
    v_add_f32 v12, 1.0, v12
    v_rcp_f32 v12, v12
    s_nop 0
    v_mul_f32 v8, v8, v12
    v_cvt_pk_bf16_f32 v8, v8, v8
    ds_write_b16 v4, v8 offset:6048

    v_mul_f32 v12, 0xbfb8aa3b, v135
    v_exp_f32 v12, v12
    v_mul_f32 v8, v135, v151
    v_add_f32 v12, 1.0, v12
    v_rcp_f32 v12, v12
    s_nop 0
    v_mul_f32 v8, v8, v12
    v_cvt_pk_bf16_f32 v8, v8, v8
    ds_write_b16 v4, v8 offset:6192

    v_mul_f32 v12, 0xbfb8aa3b, v136
    v_exp_f32 v12, v12
    v_mul_f32 v8, v136, v152
    v_add_f32 v12, 1.0, v12
    v_rcp_f32 v12, v12
    s_nop 0
    v_mul_f32 v8, v8, v12
    v_cvt_pk_bf16_f32 v8, v8, v8
    ds_write_b16 v4, v8 offset:6912

    v_mul_f32 v12, 0xbfb8aa3b, v137
    v_exp_f32 v12, v12
    v_mul_f32 v8, v137, v153
    v_add_f32 v12, 1.0, v12
    v_rcp_f32 v12, v12
    s_nop 0
    v_mul_f32 v8, v8, v12
    v_cvt_pk_bf16_f32 v8, v8, v8
    ds_write_b16 v4, v8 offset:7056

    v_mul_f32 v12, 0xbfb8aa3b, v138
    v_exp_f32 v12, v12
    v_mul_f32 v8, v138, v154
    v_add_f32 v12, 1.0, v12
    v_rcp_f32 v12, v12
    s_nop 0
    v_mul_f32 v8, v8, v12
    v_cvt_pk_bf16_f32 v8, v8, v8
    ds_write_b16 v4, v8 offset:7200

    v_mul_f32 v12, 0xbfb8aa3b, v139
    v_exp_f32 v12, v12
    v_mul_f32 v8, v139, v155
    v_add_f32 v12, 1.0, v12
    v_rcp_f32 v12, v12
    s_nop 0
    v_mul_f32 v8, v8, v12
    v_cvt_pk_bf16_f32 v8, v8, v8
    ds_write_b16 v4, v8 offset:7344

    v_mul_f32 v12, 0xbfb8aa3b, v140
    v_exp_f32 v12, v12
    v_mul_f32 v8, v140, v156
    v_add_f32 v12, 1.0, v12
    v_rcp_f32 v12, v12
    s_nop 0
    v_mul_f32 v8, v8, v12
    v_cvt_pk_bf16_f32 v8, v8, v8
    ds_write_b16 v4, v8 offset:8064

    v_mul_f32 v12, 0xbfb8aa3b, v141
    v_exp_f32 v12, v12
    v_mul_f32 v8, v141, v157
    v_add_f32 v12, 1.0, v12
    v_rcp_f32 v12, v12
    s_nop 0
    v_mul_f32 v8, v8, v12
    v_cvt_pk_bf16_f32 v8, v8, v8
    ds_write_b16 v4, v8 offset:8208

    v_mul_f32 v12, 0xbfb8aa3b, v142
    v_exp_f32 v12, v12
    v_mul_f32 v8, v142, v158
    v_add_f32 v12, 1.0, v12
    v_rcp_f32 v12, v12
    s_nop 0
    v_mul_f32 v8, v8, v12
    v_cvt_pk_bf16_f32 v8, v8, v8
    ds_write_b16 v4, v8 offset:8352

    v_mul_f32 v12, 0xbfb8aa3b, v143
    v_exp_f32 v12, v12
    v_mul_f32 v8, v143, v159
    v_add_f32 v12, 1.0, v12
    v_rcp_f32 v12, v12
    s_nop 0
    v_mul_f32 v8, v8, v12
    v_cvt_pk_bf16_f32 v8, v8, v8
    ds_write_b16 v4, v8 offset:8496

    s_waitcnt lgkmcnt(0)
    s_barrier
    v_lshrrev_b32 v1, 3, v0
    v_and_b32 v2, 7, v0
    v_mul_u32_u24 v5, 144, v1
    v_lshlrev_b32 v4, 4, v2
    v_add_u32 v5, v5, v4
    s_mul_i32 s19, s17, 256
    v_add_u32 v6, s19, v1

    ds_read_b128 v[16:19], v5 offset:0
    ds_read_b128 v[20:23], v5 offset:9216
    ds_read_b128 v[24:27], v5 offset:18432
    ds_read_b128 v[28:31], v5 offset:27648
    v_mul_u32_u24 v6, 3456, v6
    v_add_u32 v6, v6, v4
    s_lshl_b32 s26, s18, 7
    v_add_u32 v6, s26, v6
    s_add_u32 s4, s6, 16777216
    s_addc_u32 s5, s7, 0

    s_waitcnt lgkmcnt(3)
    v_add_u32 v7, 0, v6
    global_store_dwordx4 v7, v[16:19], s[4:5]
    s_waitcnt lgkmcnt(2)
    v_add_u32 v7, 221184, v6
    global_store_dwordx4 v7, v[20:23], s[4:5]
    s_waitcnt lgkmcnt(1)
    v_add_u32 v7, 442368, v6
    global_store_dwordx4 v7, v[24:27], s[4:5]
    s_waitcnt lgkmcnt(0)
    v_add_u32 v7, 663552, v6
    global_store_dwordx4 v7, v[28:31], s[4:5]
.gemm1_kernel_done:
    s_endpgm
.globl gemm2_kernel
.p2align 8
.type gemm2_kernel,@function
gemm2_kernel:
    s_cmp_ge_u32 s2, 160
    s_cbranch_scc1 .gemm2_kernel_done
    s_load_dwordx2 s[6:7], s[0:1], 136
    s_load_dwordx4 s[8:11], s[0:1], 80
    s_load_dwordx2 s[12:13], s[0:1], 96
    s_load_dwordx2 s[14:15], s[0:1], 120
    s_and_b32 s16, s2, 7
    s_mul_i32 s16, s16, 20
    s_lshr_b32 s17, s2, 3
    s_add_u32 s16, s16, s17
    s_mov_b32 s19, 429496730
    s_mul_hi_u32 s17, s16, s19
    s_mul_i32 s18, s17, 10
    s_sub_u32 s18, s16, s18
    v_lshrrev_b32 v1, 6, v0
    s_nop 0
    v_readfirstlane_b32 s23, v1
    s_waitcnt lgkmcnt(0)
    s_add_u32 s4, s6, 16777216
    s_addc_u32 s5, s7, 0

    v_and_b32 v13, 63, v0
    s_lshr_b32 s24, s23, 1
    s_and_b32 s25, s23, 1
    v_lshrrev_b32 v1, 3, v13
    v_and_b32 v2, 7, v13
    v_lshrrev_b32 v6, 4, v13
    v_xor_b32 v2, v2, v6
    v_xor_b32 v6, 4, v2
    s_mul_i32 s19, s17, 128
    s_lshl_b32 s26, s23, 5
    s_add_u32 s19, s19, s26
    v_add_u32 v3, s19, v1
    v_mul_lo_u32 v3, v3, 54
    v_lshlrev_b32 v3, 6, v3
    v_lshlrev_b32 v4, 4, v2
    v_lshlrev_b32 v6, 4, v6
    v_add_u32 v6, v3, v6
    v_add_u32 v3, v3, v4
    v_mov_b32 v5, s5
    v_add_co_u32 v4, vcc, s4, v3
    v_addc_co_u32 v5, vcc, 0, v5, vcc
    v_mov_b32 v19, s5
    v_add_co_u32 v18, vcc, s4, v6
    v_addc_co_u32 v19, vcc, 0, v19, vcc

    v_lshrrev_b32 v1, 3, v13
    v_and_b32 v2, 7, v13
    v_bfe_u32 v6, v13, 4, 1
    v_lshlrev_b32 v6, 2, v6
    v_xor_b32 v2, v2, v6
    s_lshl_b32 s26, s23, 4
    v_add_u32 v1, s26, v1
    v_mul_u32_u24 v6, 1280, v1
    v_lshlrev_b32 v7, 4, v2
    v_add_u32 v6, v6, v7
    s_lshl_b32 s20, s18, 7
    v_add_u32 v6, s20, v6
    v_mov_b32 v9, s13
    v_add_co_u32 v8, vcc, s12, v6
    v_addc_co_u32 v9, vcc, 0, v9, vcc

    v_mov_b32 v96, 0
    v_mov_b32 v97, 0
    v_mov_b32 v98, 0
    v_mov_b32 v99, 0
    v_mov_b32 v100, 0
    v_mov_b32 v101, 0
    v_mov_b32 v102, 0
    v_mov_b32 v103, 0
    v_mov_b32 v104, 0
    v_mov_b32 v105, 0
    v_mov_b32 v106, 0
    v_mov_b32 v107, 0
    v_mov_b32 v108, 0
    v_mov_b32 v109, 0
    v_mov_b32 v110, 0
    v_mov_b32 v111, 0
    v_mov_b32 v112, 0
    v_mov_b32 v113, 0
    v_mov_b32 v114, 0
    v_mov_b32 v115, 0
    v_mov_b32 v116, 0
    v_mov_b32 v117, 0
    v_mov_b32 v118, 0
    v_mov_b32 v119, 0
    v_mov_b32 v120, 0
    v_mov_b32 v121, 0
    v_mov_b32 v122, 0
    v_mov_b32 v123, 0
    v_mov_b32 v124, 0
    v_mov_b32 v125, 0
    v_mov_b32 v126, 0
    v_mov_b32 v127, 0
    v_and_b32 v1, 31, v0
    v_bfe_u32 v2, v0, 5, 1
    s_lshl_b32 s26, s24, 13
    v_lshlrev_b32 v6, 7, v1
    v_add_u32 v6, s26, v6
    v_bfe_u32 v7, v1, 1, 3

    v_add_u32 v12, 0, v2
    v_xor_b32 v12, v12, v7
    v_lshlrev_b32 v12, 4, v12
    v_add_u32 v40, v6, v12
    v_add_u32 v12, 2, v2
    v_xor_b32 v12, v12, v7
    v_lshlrev_b32 v12, 4, v12
    v_add_u32 v41, v6, v12
    v_add_u32 v12, 4, v2
    v_xor_b32 v12, v12, v7
    v_lshlrev_b32 v12, 4, v12
    v_add_u32 v42, v6, v12
    v_add_u32 v12, 6, v2
    v_xor_b32 v12, v12, v7
    v_lshlrev_b32 v12, 4, v12
    v_add_u32 v43, v6, v12
    v_bfe_u32 v6, v0, 2, 2
    v_and_b32 v7, 3, v0
    v_bfe_u32 v12, v0, 4, 1
    v_lshlrev_b32 v14, 3, v2
    v_add_u32 v14, v14, v6
    v_mul_u32_u24 v14, 128, v14
    v_add_u32 v14, 16384, v14
    v_and_b32 v15, 1, v7
    v_lshlrev_b32 v15, 3, v15
    v_add_u32 v14, v14, v15
    v_lshrrev_b32 v7, 1, v7
    v_lshlrev_b32 v12, 1, v12
    v_add_u32 v7, v7, v12
    s_lshl_b32 s26, s25, 2
    v_add_u32 v7, s26, v7

    v_lshrrev_b32 v6, 1, v6
    v_lshlrev_b32 v6, 2, v6
    v_add_u32 v12, 0, v7
    v_xor_b32 v12, v12, v6
    v_lshlrev_b32 v12, 4, v12
    v_add_u32 v44, v14, v12
    s_lshl_b32 s30, s23, 12
    s_mul_i32 s31, s23, 2048
    s_add_u32 s31, s31, 16384
    s_mov_b32 s28, 0
    s_add_u32 s29, s28, s30
    s_add_u32 m0, s29, 0
    v_add_co_u32 v14, vcc, 0, v4
    v_addc_co_u32 v15, vcc, 0, v5, vcc
    global_load_lds_dwordx4 v[14:15], off
    s_add_u32 s29, s28, s30
    s_add_u32 m0, s29, 1024
    v_add_co_u32 v14, vcc, 27648, v18
    v_addc_co_u32 v15, vcc, 0, v19, vcc
    global_load_lds_dwordx4 v[14:15], off
    s_add_u32 s29, s28, s30
    s_add_u32 m0, s29, 2048
    v_add_co_u32 v14, vcc, 55296, v4
    v_addc_co_u32 v15, vcc, 0, v5, vcc
    global_load_lds_dwordx4 v[14:15], off
    s_add_u32 s29, s28, s30
    s_add_u32 m0, s29, 3072
    v_add_co_u32 v14, vcc, 82944, v18
    v_addc_co_u32 v15, vcc, 0, v19, vcc
    global_load_lds_dwordx4 v[14:15], off
    s_add_u32 s29, s28, s31
    s_add_u32 m0, s29, 0
    v_add_co_u32 v14, vcc, 0, v8
    v_addc_co_u32 v15, vcc, 0, v9, vcc
    global_load_lds_dwordx4 v[14:15], off
    s_add_u32 s29, s28, s31
    s_add_u32 m0, s29, 1024
    v_add_co_u32 v14, vcc, 10240, v8
    v_addc_co_u32 v15, vcc, 0, v9, vcc
    global_load_lds_dwordx4 v[14:15], off
    v_add_co_u32 v4, vcc, 128, v4
    v_addc_co_u32 v5, vcc, 0, v5, vcc
    v_add_co_u32 v18, vcc, 128, v18
    v_addc_co_u32 v19, vcc, 0, v19, vcc
    v_add_co_u32 v8, vcc, 81920, v8
    v_addc_co_u32 v9, vcc, 0, v9, vcc
    s_add_u32 s28, s28, 24576
    s_cmp_eq_u32 s28, 98304
    s_cselect_b32 s28, 0, s28
    s_add_u32 s29, s28, s30
    s_add_u32 m0, s29, 0
    v_add_co_u32 v14, vcc, 0, v4
    v_addc_co_u32 v15, vcc, 0, v5, vcc
    global_load_lds_dwordx4 v[14:15], off
    s_add_u32 s29, s28, s30
    s_add_u32 m0, s29, 1024
    v_add_co_u32 v14, vcc, 27648, v18
    v_addc_co_u32 v15, vcc, 0, v19, vcc
    global_load_lds_dwordx4 v[14:15], off
    s_add_u32 s29, s28, s30
    s_add_u32 m0, s29, 2048
    v_add_co_u32 v14, vcc, 55296, v4
    v_addc_co_u32 v15, vcc, 0, v5, vcc
    global_load_lds_dwordx4 v[14:15], off
    s_add_u32 s29, s28, s30
    s_add_u32 m0, s29, 3072
    v_add_co_u32 v14, vcc, 82944, v18
    v_addc_co_u32 v15, vcc, 0, v19, vcc
    global_load_lds_dwordx4 v[14:15], off
    s_add_u32 s29, s28, s31
    s_add_u32 m0, s29, 0
    v_add_co_u32 v14, vcc, 0, v8
    v_addc_co_u32 v15, vcc, 0, v9, vcc
    global_load_lds_dwordx4 v[14:15], off
    s_add_u32 s29, s28, s31
    s_add_u32 m0, s29, 1024
    v_add_co_u32 v14, vcc, 10240, v8
    v_addc_co_u32 v15, vcc, 0, v9, vcc
    global_load_lds_dwordx4 v[14:15], off
    v_add_co_u32 v4, vcc, 128, v4
    v_addc_co_u32 v5, vcc, 0, v5, vcc
    v_add_co_u32 v18, vcc, 128, v18
    v_addc_co_u32 v19, vcc, 0, v19, vcc
    v_add_co_u32 v8, vcc, 81920, v8
    v_addc_co_u32 v9, vcc, 0, v9, vcc
    s_add_u32 s28, s28, 24576
    s_cmp_eq_u32 s28, 98304
    s_cselect_b32 s28, 0, s28
    s_add_u32 s29, s28, s30
    s_add_u32 m0, s29, 0
    v_add_co_u32 v14, vcc, 0, v4
    v_addc_co_u32 v15, vcc, 0, v5, vcc
    global_load_lds_dwordx4 v[14:15], off
    s_add_u32 s29, s28, s30
    s_add_u32 m0, s29, 1024
    v_add_co_u32 v14, vcc, 27648, v18
    v_addc_co_u32 v15, vcc, 0, v19, vcc
    global_load_lds_dwordx4 v[14:15], off
    s_add_u32 s29, s28, s30
    s_add_u32 m0, s29, 2048
    v_add_co_u32 v14, vcc, 55296, v4
    v_addc_co_u32 v15, vcc, 0, v5, vcc
    global_load_lds_dwordx4 v[14:15], off
    s_add_u32 s29, s28, s30
    s_add_u32 m0, s29, 3072
    v_add_co_u32 v14, vcc, 82944, v18
    v_addc_co_u32 v15, vcc, 0, v19, vcc
    global_load_lds_dwordx4 v[14:15], off
    s_add_u32 s29, s28, s31
    s_add_u32 m0, s29, 0
    v_add_co_u32 v14, vcc, 0, v8
    v_addc_co_u32 v15, vcc, 0, v9, vcc
    global_load_lds_dwordx4 v[14:15], off
    s_add_u32 s29, s28, s31
    s_add_u32 m0, s29, 1024
    v_add_co_u32 v14, vcc, 10240, v8
    v_addc_co_u32 v15, vcc, 0, v9, vcc
    global_load_lds_dwordx4 v[14:15], off
    v_add_co_u32 v4, vcc, 128, v4
    v_addc_co_u32 v5, vcc, 0, v5, vcc
    v_add_co_u32 v18, vcc, 128, v18
    v_addc_co_u32 v19, vcc, 0, v19, vcc
    v_add_co_u32 v8, vcc, 81920, v8
    v_addc_co_u32 v9, vcc, 0, v9, vcc
    s_add_u32 s28, s28, 24576
    s_cmp_eq_u32 s28, 98304
    s_cselect_b32 s28, 0, s28
    s_mov_b32 s27, 0
    s_mov_b32 s21, 0
.gemm2_kernel_loop:
    s_cmp_ge_u32 s27, 24
    s_cbranch_scc1 .gemm2_kernel_tail
    s_waitcnt vmcnt(12)
    s_barrier
    s_add_u32 s29, s28, s30
    s_add_u32 m0, s29, 0
    v_add_co_u32 v14, vcc, 0, v4
    v_addc_co_u32 v15, vcc, 0, v5, vcc
    global_load_lds_dwordx4 v[14:15], off
    s_add_u32 s29, s28, s30
    s_add_u32 m0, s29, 1024
    v_add_co_u32 v14, vcc, 27648, v18
    v_addc_co_u32 v15, vcc, 0, v19, vcc
    global_load_lds_dwordx4 v[14:15], off
    s_add_u32 s29, s28, s30
    s_add_u32 m0, s29, 2048
    v_add_co_u32 v14, vcc, 55296, v4
    v_addc_co_u32 v15, vcc, 0, v5, vcc
    global_load_lds_dwordx4 v[14:15], off
    s_add_u32 s29, s28, s30
    s_add_u32 m0, s29, 3072
    v_add_co_u32 v14, vcc, 82944, v18
    v_addc_co_u32 v15, vcc, 0, v19, vcc
    global_load_lds_dwordx4 v[14:15], off
    s_add_u32 s29, s28, s31
    s_add_u32 m0, s29, 0
    v_add_co_u32 v14, vcc, 0, v8
    v_addc_co_u32 v15, vcc, 0, v9, vcc
    global_load_lds_dwordx4 v[14:15], off
    s_add_u32 s29, s28, s31
    s_add_u32 m0, s29, 1024
    v_add_co_u32 v14, vcc, 10240, v8
    v_addc_co_u32 v15, vcc, 0, v9, vcc
    global_load_lds_dwordx4 v[14:15], off
    v_add_co_u32 v4, vcc, 128, v4
    v_addc_co_u32 v5, vcc, 0, v5, vcc
    v_add_co_u32 v18, vcc, 128, v18
    v_addc_co_u32 v19, vcc, 0, v19, vcc
    v_add_co_u32 v8, vcc, 81920, v8
    v_addc_co_u32 v9, vcc, 0, v9, vcc
    s_add_u32 s28, s28, 24576
    s_cmp_eq_u32 s28, 98304
    s_cselect_b32 s28, 0, s28
    s_branch .gemm2_kernel_cmp
.gemm2_kernel_tail:
    s_waitcnt vmcnt(0)
    s_barrier
.gemm2_kernel_cmp:
    ds_read_b128 v[48:51], v40 offset:0
    ds_read_b128 v[52:55], v40 offset:4096
    ds_read_b64_tr_b16 v[56:57], v44 offset:0
    ds_read_b64_tr_b16 v[58:59], v44 offset:512
    ds_read_b128 v[64:67], v41 offset:0
    ds_read_b128 v[68:71], v41 offset:4096
    ds_read_b64_tr_b16 v[72:73], v44 offset:2048
    ds_read_b64_tr_b16 v[74:75], v44 offset:2560
    s_waitcnt lgkmcnt(4)
    v_mfma_f32_32x32x16_bf16 v[96:111], v[48:51], v[56:59], v[96:111]
    v_mfma_f32_32x32x16_bf16 v[112:127], v[52:55], v[56:59], v[112:127]
    ds_read_b128 v[48:51], v42 offset:0
    ds_read_b128 v[52:55], v42 offset:4096
    ds_read_b64_tr_b16 v[56:57], v44 offset:4096
    ds_read_b64_tr_b16 v[58:59], v44 offset:4608
    s_waitcnt lgkmcnt(4)
    v_mfma_f32_32x32x16_bf16 v[96:111], v[64:67], v[72:75], v[96:111]
    v_mfma_f32_32x32x16_bf16 v[112:127], v[68:71], v[72:75], v[112:127]
    ds_read_b128 v[64:67], v43 offset:0
    ds_read_b128 v[68:71], v43 offset:4096
    ds_read_b64_tr_b16 v[72:73], v44 offset:6144
    ds_read_b64_tr_b16 v[74:75], v44 offset:6656
    s_waitcnt lgkmcnt(4)
    v_mfma_f32_32x32x16_bf16 v[96:111], v[48:51], v[56:59], v[96:111]
    v_mfma_f32_32x32x16_bf16 v[112:127], v[52:55], v[56:59], v[112:127]
    s_waitcnt lgkmcnt(0)
    v_mfma_f32_32x32x16_bf16 v[96:111], v[64:67], v[72:75], v[96:111]
    v_mfma_f32_32x32x16_bf16 v[112:127], v[68:71], v[72:75], v[112:127]
    s_add_u32 s21, s21, 24576
    s_mov_b32 s29, 24576
    s_cmp_eq_u32 s21, 98304
    s_cselect_b32 s29, 4294893568, s29
    s_cselect_b32 s21, 0, s21

    v_add_u32 v40, s29, v40
    v_add_u32 v41, s29, v41
    v_add_u32 v42, s29, v42
    v_add_u32 v43, s29, v43
    v_add_u32 v44, s29, v44
    s_add_u32 s27, s27, 1
    s_cmp_lt_u32 s27, 27
    s_cbranch_scc1 .gemm2_kernel_loop
    s_barrier
    s_nop 15
    s_nop 3
    s_mul_i32 s26, s24, 9216
    s_lshl_b32 s28, s25, 6
    s_add_u32 s26, s26, s28
    v_mul_u32_u24 v4, 576, v2
    v_lshlrev_b32 v5, 1, v1
    v_add_u32 v4, v4, v5
    v_add_u32 v4, s26, v4

    v_cvt_pk_bf16_f32 v8, v96, v96
    ds_write_b16 v4, v8 offset:0

    v_cvt_pk_bf16_f32 v8, v97, v97
    ds_write_b16 v4, v8 offset:144

    v_cvt_pk_bf16_f32 v8, v98, v98
    ds_write_b16 v4, v8 offset:288

    v_cvt_pk_bf16_f32 v8, v99, v99
    ds_write_b16 v4, v8 offset:432

    v_cvt_pk_bf16_f32 v8, v100, v100
    ds_write_b16 v4, v8 offset:1152

    v_cvt_pk_bf16_f32 v8, v101, v101
    ds_write_b16 v4, v8 offset:1296

    v_cvt_pk_bf16_f32 v8, v102, v102
    ds_write_b16 v4, v8 offset:1440

    v_cvt_pk_bf16_f32 v8, v103, v103
    ds_write_b16 v4, v8 offset:1584

    v_cvt_pk_bf16_f32 v8, v104, v104
    ds_write_b16 v4, v8 offset:2304

    v_cvt_pk_bf16_f32 v8, v105, v105
    ds_write_b16 v4, v8 offset:2448

    v_cvt_pk_bf16_f32 v8, v106, v106
    ds_write_b16 v4, v8 offset:2592

    v_cvt_pk_bf16_f32 v8, v107, v107
    ds_write_b16 v4, v8 offset:2736

    v_cvt_pk_bf16_f32 v8, v108, v108
    ds_write_b16 v4, v8 offset:3456

    v_cvt_pk_bf16_f32 v8, v109, v109
    ds_write_b16 v4, v8 offset:3600

    v_cvt_pk_bf16_f32 v8, v110, v110
    ds_write_b16 v4, v8 offset:3744

    v_cvt_pk_bf16_f32 v8, v111, v111
    ds_write_b16 v4, v8 offset:3888

    v_cvt_pk_bf16_f32 v8, v112, v112
    ds_write_b16 v4, v8 offset:4608

    v_cvt_pk_bf16_f32 v8, v113, v113
    ds_write_b16 v4, v8 offset:4752

    v_cvt_pk_bf16_f32 v8, v114, v114
    ds_write_b16 v4, v8 offset:4896

    v_cvt_pk_bf16_f32 v8, v115, v115
    ds_write_b16 v4, v8 offset:5040

    v_cvt_pk_bf16_f32 v8, v116, v116
    ds_write_b16 v4, v8 offset:5760

    v_cvt_pk_bf16_f32 v8, v117, v117
    ds_write_b16 v4, v8 offset:5904

    v_cvt_pk_bf16_f32 v8, v118, v118
    ds_write_b16 v4, v8 offset:6048

    v_cvt_pk_bf16_f32 v8, v119, v119
    ds_write_b16 v4, v8 offset:6192

    v_cvt_pk_bf16_f32 v8, v120, v120
    ds_write_b16 v4, v8 offset:6912

    v_cvt_pk_bf16_f32 v8, v121, v121
    ds_write_b16 v4, v8 offset:7056

    v_cvt_pk_bf16_f32 v8, v122, v122
    ds_write_b16 v4, v8 offset:7200

    v_cvt_pk_bf16_f32 v8, v123, v123
    ds_write_b16 v4, v8 offset:7344

    v_cvt_pk_bf16_f32 v8, v124, v124
    ds_write_b16 v4, v8 offset:8064

    v_cvt_pk_bf16_f32 v8, v125, v125
    ds_write_b16 v4, v8 offset:8208

    v_cvt_pk_bf16_f32 v8, v126, v126
    ds_write_b16 v4, v8 offset:8352

    v_cvt_pk_bf16_f32 v8, v127, v127
    ds_write_b16 v4, v8 offset:8496

    s_waitcnt lgkmcnt(0)
    s_barrier
    v_lshrrev_b32 v1, 3, v0
    v_and_b32 v2, 7, v0
    v_mul_u32_u24 v5, 144, v1
    v_lshlrev_b32 v4, 4, v2
    v_add_u32 v5, v5, v4
    s_mul_i32 s19, s17, 128
    v_add_u32 v6, s19, v1

    ds_read_b128 v[16:19], v5 offset:0
    ds_read_b128 v[20:23], v5 offset:4608
    ds_read_b128 v[24:27], v5 offset:9216
    ds_read_b128 v[28:31], v5 offset:13824
    v_mul_u32_u24 v6, 1280, v6
    v_add_u32 v6, v6, v4
    s_lshl_b32 s26, s18, 7
    v_add_u32 v6, s26, v6
    s_add_u32 s4, s6, 9437184
    s_addc_u32 s5, s7, 0
    v_lshlrev_b32 v7, 5, v2
    s_lshl_b32 s26, s18, 8
    v_add_u32 v7, s26, v7
    v_add_u32 v7, 12800, v7
    global_load_dwordx4 v[48:51], v7, s[6:7]
    global_load_dwordx4 v[52:55], v7, s[6:7] offset:16

    v_add_u32 v7, 0, v6
    global_load_dwordx4 v[32:35], v7, s[4:5]
    v_add_u32 v7, 40960, v6
    global_load_dwordx4 v[36:39], v7, s[4:5]
    v_add_u32 v7, 81920, v6
    global_load_dwordx4 v[40:43], v7, s[4:5]
    v_add_u32 v7, 122880, v6
    global_load_dwordx4 v[44:47], v7, s[4:5]
    s_waitcnt vmcnt(0) lgkmcnt(0)
    v_lshlrev_b32 v8, 16, v16
    v_and_b32 v9, 0xffff0000, v16
    v_mul_f32 v8, v8, v48
    v_mul_f32 v9, v9, v49
    v_cvt_pk_bf16_f32 v8, v8, v9
    v_lshlrev_b32 v10, 16, v8
    v_and_b32 v11, 0xffff0000, v8
    v_lshlrev_b32 v12, 16, v32
    v_and_b32 v13, 0xffff0000, v32
    v_add_f32 v10, v10, v12
    v_add_f32 v11, v11, v13
    v_cvt_pk_bf16_f32 v16, v10, v11

    v_lshlrev_b32 v8, 16, v17
    v_and_b32 v9, 0xffff0000, v17
    v_mul_f32 v8, v8, v50
    v_mul_f32 v9, v9, v51
    v_cvt_pk_bf16_f32 v8, v8, v9
    v_lshlrev_b32 v10, 16, v8
    v_and_b32 v11, 0xffff0000, v8
    v_lshlrev_b32 v12, 16, v33
    v_and_b32 v13, 0xffff0000, v33
    v_add_f32 v10, v10, v12
    v_add_f32 v11, v11, v13
    v_cvt_pk_bf16_f32 v17, v10, v11

    v_lshlrev_b32 v8, 16, v18
    v_and_b32 v9, 0xffff0000, v18
    v_mul_f32 v8, v8, v52
    v_mul_f32 v9, v9, v53
    v_cvt_pk_bf16_f32 v8, v8, v9
    v_lshlrev_b32 v10, 16, v8
    v_and_b32 v11, 0xffff0000, v8
    v_lshlrev_b32 v12, 16, v34
    v_and_b32 v13, 0xffff0000, v34
    v_add_f32 v10, v10, v12
    v_add_f32 v11, v11, v13
    v_cvt_pk_bf16_f32 v18, v10, v11

    v_lshlrev_b32 v8, 16, v19
    v_and_b32 v9, 0xffff0000, v19
    v_mul_f32 v8, v8, v54
    v_mul_f32 v9, v9, v55
    v_cvt_pk_bf16_f32 v8, v8, v9
    v_lshlrev_b32 v10, 16, v8
    v_and_b32 v11, 0xffff0000, v8
    v_lshlrev_b32 v12, 16, v35
    v_and_b32 v13, 0xffff0000, v35
    v_add_f32 v10, v10, v12
    v_add_f32 v11, v11, v13
    v_cvt_pk_bf16_f32 v19, v10, v11

    v_add_u32 v7, 0, v6
    global_store_dwordx4 v7, v[16:19], s[14:15]
    v_lshlrev_b32 v8, 16, v20
    v_and_b32 v9, 0xffff0000, v20
    v_mul_f32 v8, v8, v48
    v_mul_f32 v9, v9, v49
    v_cvt_pk_bf16_f32 v8, v8, v9
    v_lshlrev_b32 v10, 16, v8
    v_and_b32 v11, 0xffff0000, v8
    v_lshlrev_b32 v12, 16, v36
    v_and_b32 v13, 0xffff0000, v36
    v_add_f32 v10, v10, v12
    v_add_f32 v11, v11, v13
    v_cvt_pk_bf16_f32 v20, v10, v11

    v_lshlrev_b32 v8, 16, v21
    v_and_b32 v9, 0xffff0000, v21
    v_mul_f32 v8, v8, v50
    v_mul_f32 v9, v9, v51
    v_cvt_pk_bf16_f32 v8, v8, v9
    v_lshlrev_b32 v10, 16, v8
    v_and_b32 v11, 0xffff0000, v8
    v_lshlrev_b32 v12, 16, v37
    v_and_b32 v13, 0xffff0000, v37
    v_add_f32 v10, v10, v12
    v_add_f32 v11, v11, v13
    v_cvt_pk_bf16_f32 v21, v10, v11

    v_lshlrev_b32 v8, 16, v22
    v_and_b32 v9, 0xffff0000, v22
    v_mul_f32 v8, v8, v52
    v_mul_f32 v9, v9, v53
    v_cvt_pk_bf16_f32 v8, v8, v9
    v_lshlrev_b32 v10, 16, v8
    v_and_b32 v11, 0xffff0000, v8
    v_lshlrev_b32 v12, 16, v38
    v_and_b32 v13, 0xffff0000, v38
    v_add_f32 v10, v10, v12
    v_add_f32 v11, v11, v13
    v_cvt_pk_bf16_f32 v22, v10, v11

    v_lshlrev_b32 v8, 16, v23
    v_and_b32 v9, 0xffff0000, v23
    v_mul_f32 v8, v8, v54
    v_mul_f32 v9, v9, v55
    v_cvt_pk_bf16_f32 v8, v8, v9
    v_lshlrev_b32 v10, 16, v8
    v_and_b32 v11, 0xffff0000, v8
    v_lshlrev_b32 v12, 16, v39
    v_and_b32 v13, 0xffff0000, v39
    v_add_f32 v10, v10, v12
    v_add_f32 v11, v11, v13
    v_cvt_pk_bf16_f32 v23, v10, v11

    v_add_u32 v7, 40960, v6
    global_store_dwordx4 v7, v[20:23], s[14:15]
    v_lshlrev_b32 v8, 16, v24
    v_and_b32 v9, 0xffff0000, v24
    v_mul_f32 v8, v8, v48
    v_mul_f32 v9, v9, v49
    v_cvt_pk_bf16_f32 v8, v8, v9
    v_lshlrev_b32 v10, 16, v8
    v_and_b32 v11, 0xffff0000, v8
    v_lshlrev_b32 v12, 16, v40
    v_and_b32 v13, 0xffff0000, v40
    v_add_f32 v10, v10, v12
    v_add_f32 v11, v11, v13
    v_cvt_pk_bf16_f32 v24, v10, v11

    v_lshlrev_b32 v8, 16, v25
    v_and_b32 v9, 0xffff0000, v25
    v_mul_f32 v8, v8, v50
    v_mul_f32 v9, v9, v51
    v_cvt_pk_bf16_f32 v8, v8, v9
    v_lshlrev_b32 v10, 16, v8
    v_and_b32 v11, 0xffff0000, v8
    v_lshlrev_b32 v12, 16, v41
    v_and_b32 v13, 0xffff0000, v41
    v_add_f32 v10, v10, v12
    v_add_f32 v11, v11, v13
    v_cvt_pk_bf16_f32 v25, v10, v11

    v_lshlrev_b32 v8, 16, v26
    v_and_b32 v9, 0xffff0000, v26
    v_mul_f32 v8, v8, v52
    v_mul_f32 v9, v9, v53
    v_cvt_pk_bf16_f32 v8, v8, v9
    v_lshlrev_b32 v10, 16, v8
    v_and_b32 v11, 0xffff0000, v8
    v_lshlrev_b32 v12, 16, v42
    v_and_b32 v13, 0xffff0000, v42
    v_add_f32 v10, v10, v12
    v_add_f32 v11, v11, v13
    v_cvt_pk_bf16_f32 v26, v10, v11

    v_lshlrev_b32 v8, 16, v27
    v_and_b32 v9, 0xffff0000, v27
    v_mul_f32 v8, v8, v54
    v_mul_f32 v9, v9, v55
    v_cvt_pk_bf16_f32 v8, v8, v9
    v_lshlrev_b32 v10, 16, v8
    v_and_b32 v11, 0xffff0000, v8
    v_lshlrev_b32 v12, 16, v43
    v_and_b32 v13, 0xffff0000, v43
    v_add_f32 v10, v10, v12
    v_add_f32 v11, v11, v13
    v_cvt_pk_bf16_f32 v27, v10, v11

    v_add_u32 v7, 81920, v6
    global_store_dwordx4 v7, v[24:27], s[14:15]
    v_lshlrev_b32 v8, 16, v28
    v_and_b32 v9, 0xffff0000, v28
    v_mul_f32 v8, v8, v48
    v_mul_f32 v9, v9, v49
    v_cvt_pk_bf16_f32 v8, v8, v9
    v_lshlrev_b32 v10, 16, v8
    v_and_b32 v11, 0xffff0000, v8
    v_lshlrev_b32 v12, 16, v44
    v_and_b32 v13, 0xffff0000, v44
    v_add_f32 v10, v10, v12
    v_add_f32 v11, v11, v13
    v_cvt_pk_bf16_f32 v28, v10, v11

    v_lshlrev_b32 v8, 16, v29
    v_and_b32 v9, 0xffff0000, v29
    v_mul_f32 v8, v8, v50
    v_mul_f32 v9, v9, v51
    v_cvt_pk_bf16_f32 v8, v8, v9
    v_lshlrev_b32 v10, 16, v8
    v_and_b32 v11, 0xffff0000, v8
    v_lshlrev_b32 v12, 16, v45
    v_and_b32 v13, 0xffff0000, v45
    v_add_f32 v10, v10, v12
    v_add_f32 v11, v11, v13
    v_cvt_pk_bf16_f32 v29, v10, v11

    v_lshlrev_b32 v8, 16, v30
    v_and_b32 v9, 0xffff0000, v30
    v_mul_f32 v8, v8, v52
    v_mul_f32 v9, v9, v53
    v_cvt_pk_bf16_f32 v8, v8, v9
    v_lshlrev_b32 v10, 16, v8
    v_and_b32 v11, 0xffff0000, v8
    v_lshlrev_b32 v12, 16, v46
    v_and_b32 v13, 0xffff0000, v46
    v_add_f32 v10, v10, v12
    v_add_f32 v11, v11, v13
    v_cvt_pk_bf16_f32 v30, v10, v11

    v_lshlrev_b32 v8, 16, v31
    v_and_b32 v9, 0xffff0000, v31
    v_mul_f32 v8, v8, v54
    v_mul_f32 v9, v9, v55
    v_cvt_pk_bf16_f32 v8, v8, v9
    v_lshlrev_b32 v10, 16, v8
    v_and_b32 v11, 0xffff0000, v8
    v_lshlrev_b32 v12, 16, v47
    v_and_b32 v13, 0xffff0000, v47
    v_add_f32 v10, v10, v12
    v_add_f32 v11, v11, v13
    v_cvt_pk_bf16_f32 v31, v10, v11

    v_add_u32 v7, 122880, v6
    global_store_dwordx4 v7, v[28:31], s[14:15]
.gemm2_kernel_done:
    s_endpgm
.section .rodata,"a"
.p2align 6
.amdhsa_kernel prep_kernel
  .amdhsa_next_free_vgpr 148
  .amdhsa_next_free_sgpr 102
  .amdhsa_accum_offset 148
  .amdhsa_group_segment_fixed_size 0
  .amdhsa_kernarg_size 144
  .amdhsa_user_sgpr_count 2
  .amdhsa_user_sgpr_kernarg_segment_ptr 1
  .amdhsa_system_sgpr_workgroup_id_x 1
.end_amdhsa_kernel
.p2align 6
.amdhsa_kernel conv_kernel
  .amdhsa_next_free_vgpr 48
  .amdhsa_next_free_sgpr 102
  .amdhsa_accum_offset 48
  .amdhsa_group_segment_fixed_size 0
  .amdhsa_kernarg_size 144
  .amdhsa_user_sgpr_count 2
  .amdhsa_user_sgpr_kernarg_segment_ptr 1
  .amdhsa_system_sgpr_workgroup_id_x 1
.end_amdhsa_kernel
.p2align 6
.amdhsa_kernel ln2_kernel
  .amdhsa_next_free_vgpr 132
  .amdhsa_next_free_sgpr 102
  .amdhsa_accum_offset 132
  .amdhsa_group_segment_fixed_size 0
  .amdhsa_kernarg_size 144
  .amdhsa_user_sgpr_count 2
  .amdhsa_user_sgpr_kernarg_segment_ptr 1
  .amdhsa_system_sgpr_workgroup_id_x 1
.end_amdhsa_kernel
.p2align 6
.amdhsa_kernel gemm1_kernel
  .amdhsa_next_free_vgpr 160
  .amdhsa_next_free_sgpr 102
  .amdhsa_accum_offset 160
  .amdhsa_group_segment_fixed_size 0
  .amdhsa_kernarg_size 144
  .amdhsa_user_sgpr_count 2
  .amdhsa_user_sgpr_kernarg_segment_ptr 1
  .amdhsa_system_sgpr_workgroup_id_x 1
.end_amdhsa_kernel
.p2align 6
.amdhsa_kernel gemm2_kernel
  .amdhsa_next_free_vgpr 128
  .amdhsa_next_free_sgpr 102
  .amdhsa_accum_offset 128
  .amdhsa_group_segment_fixed_size 0
  .amdhsa_kernarg_size 144
  .amdhsa_user_sgpr_count 2
  .amdhsa_user_sgpr_kernarg_segment_ptr 1
  .amdhsa_system_sgpr_workgroup_id_x 1
.end_amdhsa_kernel
```
